```python
import torch

def _softmax(x, axis=-1):
    return torch.softmax(x, dim=axis)
def _gelu(x):
    return torch.nn.functional.gelu(x, approximate="tanh")
def _silu(x):
    return torch.nn.functional.silu(x)
def _sigmoid(x):
    return torch.sigmoid(x)
def _layernorm(x, axis=-1, eps=1e-5):
    m = x.mean(dim=axis, keepdim=True)
    v = x.var(dim=axis, keepdim=True, unbiased=False)
    return (x - m) / torch.sqrt(v + eps)
def _scatter_add(tgt, idx, src, axis=0):
    return tgt.clone().index_add_(axis, idx, src)
def _segment_sum(src, seg, n):
    out = torch.zeros((n,) + src.shape[1:], dtype=src.dtype)
    return out.index_add_(0, seg, src)
def _pad(x, pw):
    flat = tuple(v for pair in reversed(pw) for v in pair)
    return torch.nn.functional.pad(x, flat)

kernel_name = 'gated_mix__softmax_full_mha__softmax_full_mha__prompt'

def setup_inputs():

    _w = (lambda a: (lambda t: t.to(torch.bfloat16) if t.is_floating_point() else t)(torch.as_tensor(a)))
    def _A_setup():
        B, S, D = 1, 2048, 448
        return {
            "x": _w((lambda *s: torch.randn(*s, dtype=torch.bfloat16) * 0.05)(B, S, D)),
            "wqkv": _w((lambda *s: torch.randn(*s, dtype=torch.bfloat16) * 0.8)(D, 3 * D)),
            "wo": _w((lambda *s: torch.randn(*s, dtype=torch.bfloat16) * 0.05)(D, D)),
        }
    _A_in = _A_setup()

    def _B_setup():
        B, S, D = 1, 2048, 448
        return {
            "x": _w((lambda *s: torch.randn(*s, dtype=torch.bfloat16) * 0.05)(B, S, D)),
            "wqkv": _w((lambda *s: torch.randn(*s, dtype=torch.bfloat16) * 0.8)(D, 3 * D)),
            "wo": _w((lambda *s: torch.randn(*s, dtype=torch.bfloat16) * 0.05)(D, D)),
        }
    _B_in = _B_setup()

    return {
        "A_x": _A_in["x"],
        "A_wqkv": _A_in["wqkv"],
        "A_wo": _A_in["wo"],
        "B_x": _B_in["x"],
        "B_wqkv": _B_in["wqkv"],
        "B_wo": _B_in["wo"],
        "gate_w": _w((lambda *s: torch.randn(*s, dtype=torch.bfloat16) * 0.05)(448) * 16.0),
    }

def reference(A_x, A_wqkv, A_wo, B_x, B_wqkv, B_wo, gate_w):
    def _A_ref(x, wqkv, wo):
        B, S, D = x.shape
        H = 16; Dh = D // H
        qkv = (lambda x, *d: x.permute(*d))((x @ wqkv).reshape(B, S, 3, H, Dh), 2, 0, 3, 1, 4)
        q, k, v = qkv[0], qkv[1], qkv[2]
        scale = Dh ** -0.5
        scores = torch.einsum("bhqd,bhkd->bhqk", q, k) * scale
        p = _softmax(scores, axis=-1)
        o = torch.einsum("bhqk,bhkd->bhqd", p, v)
        return (lambda x, *d: x.permute(*d))(o, 0, 2, 1, 3).reshape(B, S, D) @ wo

    def _B_ref(x, wqkv, wo):
        B, S, D = x.shape
        H = 16; Dh = D // H
        qkv = (lambda x, *d: x.permute(*d))((x @ wqkv).reshape(B, S, 3, H, Dh), 2, 0, 3, 1, 4)
        q, k, v = qkv[0], qkv[1], qkv[2]
        scale = Dh ** -0.5
        scores = torch.einsum("bhqd,bhkd->bhqk", q, k) * scale
        p = _softmax(scores, axis=-1)
        o = torch.einsum("bhqk,bhkd->bhqd", p, v)
        return (lambda x, *d: x.permute(*d))(o, 0, 2, 1, 3).reshape(B, S, D) @ wo

    x = A_x
    g = _sigmoid((x * gate_w).sum(-1, keepdims=True))
    a = _A_ref(x, A_wqkv, A_wo)
    b = _B_ref(x, B_wqkv, B_wo)
    return g * a + (1 - g) * b
```

```asm
; @launch grid=(256,1,1) block=(512,1,1) lds=160000
.amdgcn_target "amdgcn-amd-amdhsa--gfx950"
.text
.globl gated_mix__softmax_full_mha__softmax_full_mha__prompt_kernel
.p2align 8
.type gated_mix__softmax_full_mha__softmax_full_mha__prompt_kernel,@function
gated_mix__softmax_full_mha__softmax_full_mha__prompt_kernel:
    s_cmp_ge_u32 s2, 256
    s_cbranch_scc1 L_END
    s_load_dwordx16 s[36:51], s[0:1], 0
    s_load_dwordx4 s[52:55], s[0:1], 64
    s_memrealtime s[68:69]
    s_and_b32 s59, s2, 7
    s_lshr_b32 s62, s2, 3
    s_and_b32 s56, s59, 1
    s_lshl_b32 s56, s56, 4
    s_and_b32 s63, s62, 15
    s_add_u32 s56, s56, s63
    s_lshr_b32 s57, s59, 1
    s_lshl_b32 s57, s57, 1
    s_lshr_b32 s62, s62, 4
    s_add_u32 s57, s57, s62
    s_and_b32 s63, s63, 7
    s_lshl_b32 s62, s62, 1
    s_add_u32 s61, s62, s63
    s_add_u32 s61, s61, s59
    s_mul_i32 s62, s61, 37
    s_lshr_b32 s62, s62, 8
    s_mul_i32 s62, s62, 7
    s_sub_u32 s61, s61, s62
    v_lshrrev_b32 v1, 6, v0
    v_and_b32 v2, 63, v0
    v_readfirstlane_b32 s58, v1
    v_lshlrev_b32 v3, 4, v2
    s_lshl_b32 s60, s57, 3
    s_nop 2
    s_add_u32 s60, s60, s58
    s_lshl_b32 s76, s58, 12
    s_add_u32 s65, s76, 126976
    s_add_u32 s66, s76, 86016
    v_lshrrev_b32 v4, 3, v2
    v_and_b32 v5, 7, v2
    s_lshl_b32 s59, s60, 5
    v_add_u32 v6, s59, v4
    v_mul_u32_u24 v6, 896, v6
    v_lshrrev_b32 v7, 1, v4
    v_xor_b32 v8, v7, v5
    v_or_b32 v7, 4, v7
    v_xor_b32 v7, v7, v5
    v_lshl_add_u32 v96, v8, 4, v6
    v_lshl_add_u32 v7, v7, 4, v6
    v_add_u32 v97, 6144, v7
    v_add_u32 v98, 12288, v96
    v_add_u32 v99, 18432, v7
    v_mul_u32_u24 v5, 43, v2
    v_lshrrev_b32 v5, 9, v5
    v_mul_u32_u24 v6, 12, v5
    v_sub_u32 v6, v2, v6
    v_lshl_add_u32 v5, v1, 3, v5
    v_mul_u32_u24 v5, 2688, v5
    v_lshrrev_b32 v7, 2, v6
    v_mul_u32_u24 v7, 896, v7
    v_add_u32 v5, v5, v7
    v_and_b32 v6, 3, v6
    v_lshl_add_u32 v5, v6, 4, v5
    s_and_b32 s59, s56, 15
    s_mul_i32 s59, s59, 56
    v_add_u32 v104, s59, v5
    s_mul_i32 s67, s58, 1536
    s_waitcnt lgkmcnt(0)
    s_mov_b32 s4, s36
    s_mov_b32 s5, s37
    s_mov_b32 s6, 1835008
    s_mov_b32 s7, 0x00020000
    s_cmp_ge_u32 s56, 16
    s_cselect_b32 s8, s44, s38
    s_cselect_b32 s9, s45, s39
    s_mov_b32 s10, 1204224
    s_mov_b32 s11, 0x00020000
    s_add_u32 s62, s61, 0
    s_sub_u32 s63, s62, 7
    s_min_u32 s62, s62, s63
    s_mov_b32 m0, s65
    s_lshl_b32 s63, s62, 7
    buffer_load_dwordx4 v96, s[4:7], s63 offen offset:0 lds
    buffer_load_dwordx4 v97, s[4:7], s63 offen offset:1024 lds
    buffer_load_dwordx4 v98, s[4:7], s63 offen offset:2048 lds
    buffer_load_dwordx4 v99, s[4:7], s63 offen offset:3072 lds
    s_add_u32 s62, s61, 0
    s_sub_u32 s63, s62, 7
    s_min_u32 s62, s62, s63
    s_mov_b32 exec_hi, 0xffff
    s_mul_i32 s62, s62, 172032
    s_add_u32 m0, s67, 0
    s_add_u32 s63, s62, 9984
    buffer_load_dwordx4 v104, s[8:11], s62 offen lds
    buffer_load_dwordx4 v104, s[8:11], s63 offen offset:768 lds
    s_mov_b32 exec_hi, -1
    s_add_u32 s62, s61, 1
    s_sub_u32 s63, s62, 7
    s_min_u32 s62, s62, s63
    s_mov_b32 m0, s66
    s_lshl_b32 s63, s62, 7
    buffer_load_dwordx4 v96, s[4:7], s63 offen offset:0 lds
    buffer_load_dwordx4 v97, s[4:7], s63 offen offset:1024 lds
    buffer_load_dwordx4 v98, s[4:7], s63 offen offset:2048 lds
    buffer_load_dwordx4 v99, s[4:7], s63 offen offset:3072 lds
    s_add_u32 s62, s61, 1
    s_sub_u32 s63, s62, 7
    s_min_u32 s62, s62, s63
    s_mov_b32 exec_hi, 0xffff
    s_mul_i32 s62, s62, 172032
    s_add_u32 m0, s67, 12288
    s_add_u32 s63, s62, 9984
    buffer_load_dwordx4 v104, s[8:11], s62 offen lds
    buffer_load_dwordx4 v104, s[8:11], s63 offen offset:768 lds
    s_mov_b32 exec_hi, -1
    s_mov_b32 s20, s48
    s_mov_b32 s21, s49
    s_mov_b32 s22, 896
    s_mov_b32 s23, 0x00020000
    s_mov_b32 s12, s54
    s_mov_b32 s13, s55
    s_mov_b32 s14, 13631488
    s_mov_b32 s15, 0x00020000
    s_mov_b32 s28, s50
    s_mov_b32 s29, s51
    s_mov_b32 s30, 1835008
    s_mov_b32 s31, 0x00020000
    s_mov_b32 s32, s52
    s_mov_b32 s33, s53
    s_mov_b32 s34, 256
    s_mov_b32 s35, 0x00020000
    s_cmp_ge_u32 s58, 4
    s_cselect_b32 s16, s46, s40
    s_cselect_b32 s17, s47, s41
    s_sub_u32 s16, s16, 4096
    s_subb_u32 s17, s17, 0
    s_mov_b32 s18, 405504
    s_mov_b32 s19, 0x00020000
    s_lshl_b32 s59, s56, 18
    s_add_u32 s24, s54, s59
    s_addc_u32 s25, s55, 0
    s_mov_b32 s26, 262144
    s_mov_b32 s27, 0x00020000
    s_or_b32 s68, s68, 1
    s_or_b32 s59, s2, s58
    s_cmp_lg_u32 s59, 0
    s_cbranch_scc1 L_NOTAG
    v_mov_b32 v4, s68
    v_mov_b32 v5, s69
    v_mov_b32 v6, 0
    s_mov_b64 exec, 1
    buffer_store_dwordx2 v[4:5], v6, s[32:35], 0 offen sc1
    s_mov_b64 exec, -1
L_NOTAG:
    v_and_b32 v4, 31, v2
    v_lshrrev_b32 v5, 5, v2
    v_lshrrev_b32 v6, 1, v4
    v_and_b32 v6, 7, v6
    v_lshlrev_b32 v7, 7, v4
    v_add_u32 v7, s66, v7
    v_add_u32 v8, 0, v5
    v_xor_b32 v8, v8, v6
    v_lshl_add_u32 v100, v8, 4, v7
    v_add_u32 v8, 2, v5
    v_xor_b32 v8, v8, v6
    v_lshl_add_u32 v101, v8, 4, v7
    v_add_u32 v8, 4, v5
    v_xor_b32 v8, v8, v6
    v_lshl_add_u32 v102, v8, 4, v7
    v_add_u32 v8, 6, v5
    v_xor_b32 v8, v8, v6
    v_lshl_add_u32 v103, v8, 4, v7
    v_bfe_u32 v6, v2, 2, 2
    v_lshl_add_u32 v6, v5, 3, v6
    v_mul_u32_u24 v6, 192, v6
    v_bfe_u32 v7, v2, 4, 1
    v_lshl_add_u32 v6, v7, 5, v6
    v_and_b32 v7, 3, v2
    v_lshl_add_u32 v105, v7, 3, v6
    v_add_u32 v106, 43008, v105
    s_and_b32 s62, s58, 3
    s_lshr_b32 s63, s58, 2
    s_mov_b32 s48, s63
    s_lshl_b32 s59, s62, 1
    s_add_u32 s44, s59, s63
    s_lshl_b32 s59, s44, 12
    s_add_u32 s59, s59, 86016
    v_add_u32 v121, s59, v3
    s_xor_b32 s59, s44, 1
    s_lshl_b32 s59, s59, 12
    s_add_u32 s59, s59, 86016
    v_add_u32 v122, s59, v3
    s_lshl_b32 s59, s63, 12
    v_add_u32 v120, s59, v3
    v_add_u32 v114, s76, v3
    s_lshl_b32 s59, s56, 3
    s_add_u32 s59, s59, s58
    s_lshl_b32 s59, s59, 6
    s_add_u32 s59, s59, 12582912
    v_add_u32 v5, s57, v2
    v_and_b32 v5, 7, v5
    v_lshl_add_u32 v115, v5, 3, s59
    s_mov_b32 s77, 0
    s_mov_b32 s70, 1
    s_and_b32 s59, s56, 3
    s_lshl_b32 s3, s59, 2
    s_cmp_eq_u32 s59, 3
    s_cselect_b32 s3, 11, s3
    v_lshrrev_b32 v4, 4, v2
    v_mul_u32_u24 v5, 3584, v4
    v_and_b32 v6, 15, v2
    v_lshl_add_u32 v5, v6, 4, v5
    s_lshl_b32 s59, s3, 6
    v_add_u32 v116, s59, v5
    s_mul_i32 s45, s58, 4352
    s_add_u32 s45, s45, 65536
    v_bfe_u32 v4, v2, 2, 2
    v_mul_u32_u24 v4, 1088, v4
    v_lshrrev_b32 v5, 5, v2
    v_lshl_add_u32 v4, v5, 8, v4
    v_bfe_u32 v6, v2, 4, 1
    v_lshl_add_u32 v4, v6, 5, v4
    v_and_b32 v6, 3, v2
    v_lshl_add_u32 v4, v6, 3, v4
    v_add_u32 v117, s45, v4
    s_mul_i32 s46, s62, 100352
    s_add_u32 s46, s46, 4096
    s_mov_b32 s47, 14336
    v_mov_b32 v6, 159744
    v_mov_b32 v7, 0
    ds_write_b32 v6, v7
    v_mov_b32 v16, 0
    v_mov_b32 v17, 0
    v_mov_b32 v18, 0
    v_mov_b32 v19, 0
    v_mov_b32 v20, 0
    v_mov_b32 v21, 0
    v_mov_b32 v22, 0
    v_mov_b32 v23, 0
    v_mov_b32 v24, 0
    v_mov_b32 v25, 0
    v_mov_b32 v26, 0
    v_mov_b32 v27, 0
    v_mov_b32 v28, 0
    v_mov_b32 v29, 0
    v_mov_b32 v30, 0
    v_mov_b32 v31, 0
    v_mov_b32 v32, 0
    v_mov_b32 v33, 0
    v_mov_b32 v34, 0
    v_mov_b32 v35, 0
    v_mov_b32 v36, 0
    v_mov_b32 v37, 0
    v_mov_b32 v38, 0
    v_mov_b32 v39, 0
    v_mov_b32 v40, 0
    v_mov_b32 v41, 0
    v_mov_b32 v42, 0
    v_mov_b32 v43, 0
    v_mov_b32 v44, 0
    v_mov_b32 v45, 0
    v_mov_b32 v46, 0
    v_mov_b32 v47, 0
    v_mov_b32 v48, 0
    v_mov_b32 v49, 0
    v_mov_b32 v50, 0
    v_mov_b32 v51, 0
    v_mov_b32 v52, 0
    v_mov_b32 v53, 0
    v_mov_b32 v54, 0
    v_mov_b32 v55, 0
    v_mov_b32 v56, 0
    v_mov_b32 v57, 0
    v_mov_b32 v58, 0
    v_mov_b32 v59, 0
    v_mov_b32 v60, 0
    v_mov_b32 v61, 0
    v_mov_b32 v62, 0
    v_mov_b32 v63, 0
    s_waitcnt vmcnt(8)
    ds_read_b128 v[64:67], v100 offset:40960
    ds_read_b128 v[68:71], v101 offset:40960
    ds_read_b128 v[72:75], v102 offset:40960
    ds_read_b128 v[76:79], v103 offset:40960
    s_waitcnt vmcnt(6)
    s_barrier
    ds_read_b64_tr_b16 a[4:5], v105 offset:64
    ds_read_b64_tr_b16 a[6:7], v105 offset:832
    ds_read_b64_tr_b16 a[8:9], v105 offset:128
    ds_read_b64_tr_b16 a[10:11], v105 offset:896
    ds_read_b64_tr_b16 a[0:1], v105 offset:0
    ds_read_b64_tr_b16 a[2:3], v105 offset:768
    s_waitcnt lgkmcnt(6)
    s_add_u32 s62, s61, 2
    s_sub_u32 s63, s62, 7
    s_min_u32 s62, s62, s63
    s_mov_b32 m0, s65
    s_lshl_b32 s63, s62, 7
    buffer_load_dwordx4 v96, s[4:7], s63 offen offset:0 lds
    buffer_load_dwordx4 v97, s[4:7], s63 offen offset:1024 lds
    buffer_load_dwordx4 v98, s[4:7], s63 offen offset:2048 lds
    buffer_load_dwordx4 v99, s[4:7], s63 offen offset:3072 lds
    s_add_u32 s62, s61, 2
    s_sub_u32 s63, s62, 7
    s_min_u32 s62, s62, s63
    s_mov_b32 exec_hi, 0xffff
    s_mul_i32 s62, s62, 172032
    s_add_u32 m0, s67, 24576
    s_add_u32 s63, s62, 9984
    buffer_load_dwordx4 v104, s[8:11], s62 offen lds
    buffer_load_dwordx4 v104, s[8:11], s63 offen offset:768 lds
    s_mov_b32 exec_hi, -1
    ds_read_b64_tr_b16 a[16:17], v105 offset:3136
    ds_read_b64_tr_b16 a[18:19], v105 offset:3904
    ds_read_b64_tr_b16 a[20:21], v105 offset:3200
    ds_read_b64_tr_b16 a[22:23], v105 offset:3968
    ds_read_b64_tr_b16 a[12:13], v105 offset:3072
    ds_read_b64_tr_b16 a[14:15], v105 offset:3840
    s_waitcnt lgkmcnt(6)
    v_mfma_f32_32x32x16_bf16 v[32:47], a[4:7], v[64:67], v[32:47]
    v_mfma_f32_32x32x16_bf16 v[48:63], v[64:67], a[8:11], v[48:63]
    v_mfma_f32_32x32x16_bf16 v[16:31], a[0:3], v[64:67], v[16:31]
    ds_read_b64_tr_b16 a[4:5], v105 offset:6208
    ds_read_b64_tr_b16 a[6:7], v105 offset:6976
    ds_read_b64_tr_b16 a[8:9], v105 offset:6272
    ds_read_b64_tr_b16 a[10:11], v105 offset:7040
    ds_read_b64_tr_b16 a[0:1], v105 offset:6144
    ds_read_b64_tr_b16 a[2:3], v105 offset:6912
    s_waitcnt lgkmcnt(6)
    v_mfma_f32_32x32x16_bf16 v[32:47], a[16:19], v[68:71], v[32:47]
    v_mfma_f32_32x32x16_bf16 v[48:63], v[68:71], a[20:23], v[48:63]
    v_mfma_f32_32x32x16_bf16 v[16:31], a[12:15], v[68:71], v[16:31]
    s_waitcnt vmcnt(8)
    ds_read_b128 v[80:83], v100 offset:0
    ds_read_b128 v[84:87], v101 offset:0
    ds_read_b128 v[88:91], v102 offset:0
    ds_read_b128 v[92:95], v103 offset:0
    ds_read_b64_tr_b16 a[16:17], v105 offset:9280
    ds_read_b64_tr_b16 a[18:19], v105 offset:10048
    ds_read_b64_tr_b16 a[20:21], v105 offset:9344
    ds_read_b64_tr_b16 a[22:23], v105 offset:10112
    ds_read_b64_tr_b16 a[12:13], v105 offset:9216
    ds_read_b64_tr_b16 a[14:15], v105 offset:9984
    s_waitcnt lgkmcnt(10)
    v_mfma_f32_32x32x16_bf16 v[32:47], a[4:7], v[72:75], v[32:47]
    v_mfma_f32_32x32x16_bf16 v[48:63], v[72:75], a[8:11], v[48:63]
    v_mfma_f32_32x32x16_bf16 v[16:31], a[0:3], v[72:75], v[16:31]
    s_waitcnt vmcnt(6)
    s_barrier
    ds_read_b64_tr_b16 a[4:5], v105 offset:12352
    ds_read_b64_tr_b16 a[6:7], v105 offset:13120
    ds_read_b64_tr_b16 a[8:9], v105 offset:12416
    ds_read_b64_tr_b16 a[10:11], v105 offset:13184
    ds_read_b64_tr_b16 a[0:1], v105 offset:12288
    ds_read_b64_tr_b16 a[2:3], v105 offset:13056
    s_waitcnt lgkmcnt(6)
    v_mfma_f32_32x32x16_bf16 v[32:47], a[16:19], v[76:79], v[32:47]
    v_mfma_f32_32x32x16_bf16 v[48:63], v[76:79], a[20:23], v[48:63]
    v_mfma_f32_32x32x16_bf16 v[16:31], a[12:15], v[76:79], v[16:31]
    s_add_u32 s62, s61, 3
    s_sub_u32 s63, s62, 7
    s_min_u32 s62, s62, s63
    s_mov_b32 m0, s66
    s_lshl_b32 s63, s62, 7
    buffer_load_dwordx4 v96, s[4:7], s63 offen offset:0 lds
    buffer_load_dwordx4 v97, s[4:7], s63 offen offset:1024 lds
    buffer_load_dwordx4 v98, s[4:7], s63 offen offset:2048 lds
    buffer_load_dwordx4 v99, s[4:7], s63 offen offset:3072 lds
    s_add_u32 s62, s61, 3
    s_sub_u32 s63, s62, 7
    s_min_u32 s62, s62, s63
    s_mov_b32 exec_hi, 0xffff
    s_mul_i32 s62, s62, 172032
    s_add_u32 m0, s67, 36864
    s_add_u32 s63, s62, 9984
    buffer_load_dwordx4 v104, s[8:11], s62 offen lds
    buffer_load_dwordx4 v104, s[8:11], s63 offen offset:768 lds
    s_mov_b32 exec_hi, -1
    ds_read_b64_tr_b16 a[16:17], v105 offset:15424
    ds_read_b64_tr_b16 a[18:19], v105 offset:16192
    ds_read_b64_tr_b16 a[20:21], v105 offset:15488
    ds_read_b64_tr_b16 a[22:23], v105 offset:16256
    ds_read_b64_tr_b16 a[12:13], v105 offset:15360
    ds_read_b64_tr_b16 a[14:15], v105 offset:16128
    s_waitcnt lgkmcnt(6)
    v_mfma_f32_32x32x16_bf16 v[32:47], a[4:7], v[80:83], v[32:47]
    v_mfma_f32_32x32x16_bf16 v[48:63], v[80:83], a[8:11], v[48:63]
    v_mfma_f32_32x32x16_bf16 v[16:31], a[0:3], v[80:83], v[16:31]
    ds_read_b64_tr_b16 a[4:5], v105 offset:18496
    ds_read_b64_tr_b16 a[6:7], v105 offset:19264
    ds_read_b64_tr_b16 a[8:9], v105 offset:18560
    ds_read_b64_tr_b16 a[10:11], v105 offset:19328
    ds_read_b64_tr_b16 a[0:1], v105 offset:18432
    ds_read_b64_tr_b16 a[2:3], v105 offset:19200
    s_waitcnt lgkmcnt(6)
    v_mfma_f32_32x32x16_bf16 v[32:47], a[16:19], v[84:87], v[32:47]
    v_mfma_f32_32x32x16_bf16 v[48:63], v[84:87], a[20:23], v[48:63]
    v_mfma_f32_32x32x16_bf16 v[16:31], a[12:15], v[84:87], v[16:31]
    s_waitcnt vmcnt(8)
    ds_read_b128 v[64:67], v100 offset:40960
    ds_read_b128 v[68:71], v101 offset:40960
    ds_read_b128 v[72:75], v102 offset:40960
    ds_read_b128 v[76:79], v103 offset:40960
    ds_read_b64_tr_b16 a[16:17], v105 offset:21568
    ds_read_b64_tr_b16 a[18:19], v105 offset:22336
    ds_read_b64_tr_b16 a[20:21], v105 offset:21632
    ds_read_b64_tr_b16 a[22:23], v105 offset:22400
    ds_read_b64_tr_b16 a[12:13], v105 offset:21504
    ds_read_b64_tr_b16 a[14:15], v105 offset:22272
    s_waitcnt lgkmcnt(10)
    v_mfma_f32_32x32x16_bf16 v[32:47], a[4:7], v[88:91], v[32:47]
    v_mfma_f32_32x32x16_bf16 v[48:63], v[88:91], a[8:11], v[48:63]
    v_mfma_f32_32x32x16_bf16 v[16:31], a[0:3], v[88:91], v[16:31]
    s_waitcnt vmcnt(6)
    s_barrier
    ds_read_b64_tr_b16 a[4:5], v105 offset:24640
    ds_read_b64_tr_b16 a[6:7], v105 offset:25408
    ds_read_b64_tr_b16 a[8:9], v105 offset:24704
    ds_read_b64_tr_b16 a[10:11], v105 offset:25472
    ds_read_b64_tr_b16 a[0:1], v105 offset:24576
    ds_read_b64_tr_b16 a[2:3], v105 offset:25344
    s_waitcnt lgkmcnt(6)
    v_mfma_f32_32x32x16_bf16 v[32:47], a[16:19], v[92:95], v[32:47]
    v_mfma_f32_32x32x16_bf16 v[48:63], v[92:95], a[20:23], v[48:63]
    v_mfma_f32_32x32x16_bf16 v[16:31], a[12:15], v[92:95], v[16:31]
    s_add_u32 s62, s61, 4
    s_sub_u32 s63, s62, 7
    s_min_u32 s62, s62, s63
    s_mov_b32 m0, s65
    s_lshl_b32 s63, s62, 7
    buffer_load_dwordx4 v96, s[4:7], s63 offen offset:0 lds
    buffer_load_dwordx4 v97, s[4:7], s63 offen offset:1024 lds
    buffer_load_dwordx4 v98, s[4:7], s63 offen offset:2048 lds
    buffer_load_dwordx4 v99, s[4:7], s63 offen offset:3072 lds
    s_add_u32 s62, s61, 4
    s_sub_u32 s63, s62, 7
    s_min_u32 s62, s62, s63
    s_mov_b32 exec_hi, 0xffff
    s_mul_i32 s62, s62, 172032
    s_add_u32 m0, s67, 49152
    s_add_u32 s63, s62, 9984
    buffer_load_dwordx4 v104, s[8:11], s62 offen lds
    buffer_load_dwordx4 v104, s[8:11], s63 offen offset:768 lds
    s_mov_b32 exec_hi, -1
    ds_read_b64_tr_b16 a[16:17], v105 offset:27712
    ds_read_b64_tr_b16 a[18:19], v105 offset:28480
    ds_read_b64_tr_b16 a[20:21], v105 offset:27776
    ds_read_b64_tr_b16 a[22:23], v105 offset:28544
    ds_read_b64_tr_b16 a[12:13], v105 offset:27648
    ds_read_b64_tr_b16 a[14:15], v105 offset:28416
    s_waitcnt lgkmcnt(6)
    v_mfma_f32_32x32x16_bf16 v[32:47], a[4:7], v[64:67], v[32:47]
    v_mfma_f32_32x32x16_bf16 v[48:63], v[64:67], a[8:11], v[48:63]
    v_mfma_f32_32x32x16_bf16 v[16:31], a[0:3], v[64:67], v[16:31]
    ds_read_b64_tr_b16 a[4:5], v105 offset:30784
    ds_read_b64_tr_b16 a[6:7], v105 offset:31552
    ds_read_b64_tr_b16 a[8:9], v105 offset:30848
    ds_read_b64_tr_b16 a[10:11], v105 offset:31616
    ds_read_b64_tr_b16 a[0:1], v105 offset:30720
    ds_read_b64_tr_b16 a[2:3], v105 offset:31488
    s_waitcnt lgkmcnt(6)
    v_mfma_f32_32x32x16_bf16 v[32:47], a[16:19], v[68:71], v[32:47]
    v_mfma_f32_32x32x16_bf16 v[48:63], v[68:71], a[20:23], v[48:63]
    v_mfma_f32_32x32x16_bf16 v[16:31], a[12:15], v[68:71], v[16:31]
    s_waitcnt vmcnt(8)
    ds_read_b128 v[80:83], v100 offset:0
    ds_read_b128 v[84:87], v101 offset:0
    ds_read_b128 v[88:91], v102 offset:0
    ds_read_b128 v[92:95], v103 offset:0
    ds_read_b64_tr_b16 a[16:17], v105 offset:33856
    ds_read_b64_tr_b16 a[18:19], v105 offset:34624
    ds_read_b64_tr_b16 a[20:21], v105 offset:33920
    ds_read_b64_tr_b16 a[22:23], v105 offset:34688
    ds_read_b64_tr_b16 a[12:13], v105 offset:33792
    ds_read_b64_tr_b16 a[14:15], v105 offset:34560
    s_waitcnt lgkmcnt(10)
    v_mfma_f32_32x32x16_bf16 v[32:47], a[4:7], v[72:75], v[32:47]
    v_mfma_f32_32x32x16_bf16 v[48:63], v[72:75], a[8:11], v[48:63]
    v_mfma_f32_32x32x16_bf16 v[16:31], a[0:3], v[72:75], v[16:31]
    s_waitcnt vmcnt(6)
    s_barrier
    ds_read_b64_tr_b16 a[4:5], v105 offset:36928
    ds_read_b64_tr_b16 a[6:7], v105 offset:37696
    ds_read_b64_tr_b16 a[8:9], v105 offset:36992
    ds_read_b64_tr_b16 a[10:11], v105 offset:37760
    ds_read_b64_tr_b16 a[0:1], v105 offset:36864
    ds_read_b64_tr_b16 a[2:3], v105 offset:37632
    s_waitcnt lgkmcnt(6)
    v_mfma_f32_32x32x16_bf16 v[32:47], a[16:19], v[76:79], v[32:47]
    v_mfma_f32_32x32x16_bf16 v[48:63], v[76:79], a[20:23], v[48:63]
    v_mfma_f32_32x32x16_bf16 v[16:31], a[12:15], v[76:79], v[16:31]
    s_add_u32 s62, s61, 5
    s_sub_u32 s63, s62, 7
    s_min_u32 s62, s62, s63
    s_mov_b32 m0, s66
    s_lshl_b32 s63, s62, 7
    buffer_load_dwordx4 v96, s[4:7], s63 offen offset:0 lds
    buffer_load_dwordx4 v97, s[4:7], s63 offen offset:1024 lds
    buffer_load_dwordx4 v98, s[4:7], s63 offen offset:2048 lds
    buffer_load_dwordx4 v99, s[4:7], s63 offen offset:3072 lds
    s_add_u32 s62, s61, 5
    s_sub_u32 s63, s62, 7
    s_min_u32 s62, s62, s63
    s_mov_b32 exec_hi, 0xffff
    s_mul_i32 s62, s62, 172032
    s_add_u32 m0, s67, 61440
    s_add_u32 s63, s62, 9984
    buffer_load_dwordx4 v104, s[8:11], s62 offen lds
    buffer_load_dwordx4 v104, s[8:11], s63 offen offset:768 lds
    s_mov_b32 exec_hi, -1
    ds_read_b64_tr_b16 a[16:17], v105 offset:40000
    ds_read_b64_tr_b16 a[18:19], v105 offset:40768
    ds_read_b64_tr_b16 a[20:21], v105 offset:40064
    ds_read_b64_tr_b16 a[22:23], v105 offset:40832
    ds_read_b64_tr_b16 a[12:13], v105 offset:39936
    ds_read_b64_tr_b16 a[14:15], v105 offset:40704
    s_waitcnt lgkmcnt(6)
    v_mfma_f32_32x32x16_bf16 v[32:47], a[4:7], v[80:83], v[32:47]
    v_mfma_f32_32x32x16_bf16 v[48:63], v[80:83], a[8:11], v[48:63]
    v_mfma_f32_32x32x16_bf16 v[16:31], a[0:3], v[80:83], v[16:31]
    ds_read_b64_tr_b16 a[4:5], v106 offset:64
    ds_read_b64_tr_b16 a[6:7], v106 offset:832
    ds_read_b64_tr_b16 a[8:9], v106 offset:128
    ds_read_b64_tr_b16 a[10:11], v106 offset:896
    ds_read_b64_tr_b16 a[0:1], v106 offset:0
    ds_read_b64_tr_b16 a[2:3], v106 offset:768
    s_waitcnt lgkmcnt(6)
    v_mfma_f32_32x32x16_bf16 v[32:47], a[16:19], v[84:87], v[32:47]
    v_mfma_f32_32x32x16_bf16 v[48:63], v[84:87], a[20:23], v[48:63]
    v_mfma_f32_32x32x16_bf16 v[16:31], a[12:15], v[84:87], v[16:31]
    s_waitcnt vmcnt(8)
    ds_read_b128 v[64:67], v100 offset:40960
    ds_read_b128 v[68:71], v101 offset:40960
    ds_read_b128 v[72:75], v102 offset:40960
    ds_read_b128 v[76:79], v103 offset:40960
    ds_read_b64_tr_b16 a[16:17], v106 offset:3136
    ds_read_b64_tr_b16 a[18:19], v106 offset:3904
    ds_read_b64_tr_b16 a[20:21], v106 offset:3200
    ds_read_b64_tr_b16 a[22:23], v106 offset:3968
    ds_read_b64_tr_b16 a[12:13], v106 offset:3072
    ds_read_b64_tr_b16 a[14:15], v106 offset:3840
    s_waitcnt lgkmcnt(10)
    v_mfma_f32_32x32x16_bf16 v[32:47], a[4:7], v[88:91], v[32:47]
    v_mfma_f32_32x32x16_bf16 v[48:63], v[88:91], a[8:11], v[48:63]
    v_mfma_f32_32x32x16_bf16 v[16:31], a[0:3], v[88:91], v[16:31]
    s_waitcnt vmcnt(6)
    s_barrier
    ds_read_b64_tr_b16 a[4:5], v106 offset:6208
    ds_read_b64_tr_b16 a[6:7], v106 offset:6976
    ds_read_b64_tr_b16 a[8:9], v106 offset:6272
    ds_read_b64_tr_b16 a[10:11], v106 offset:7040
    ds_read_b64_tr_b16 a[0:1], v106 offset:6144
    ds_read_b64_tr_b16 a[2:3], v106 offset:6912
    s_waitcnt lgkmcnt(6)
    v_mfma_f32_32x32x16_bf16 v[32:47], a[16:19], v[92:95], v[32:47]
    v_mfma_f32_32x32x16_bf16 v[48:63], v[92:95], a[20:23], v[48:63]
    v_mfma_f32_32x32x16_bf16 v[16:31], a[12:15], v[92:95], v[16:31]
    s_add_u32 s62, s61, 6
    s_sub_u32 s63, s62, 7
    s_min_u32 s62, s62, s63
    s_mov_b32 m0, s65
    s_lshl_b32 s63, s62, 7
    buffer_load_dwordx4 v96, s[4:7], s63 offen offset:0 lds
    buffer_load_dwordx4 v97, s[4:7], s63 offen offset:1024 lds
    buffer_load_dwordx4 v98, s[4:7], s63 offen offset:2048 lds
    buffer_load_dwordx4 v99, s[4:7], s63 offen offset:3072 lds
    s_add_u32 s62, s61, 6
    s_sub_u32 s63, s62, 7
    s_min_u32 s62, s62, s63
    s_mov_b32 exec_hi, 0xffff
    s_mul_i32 s62, s62, 172032
    s_add_u32 m0, s67, 73728
    s_add_u32 s63, s62, 9984
    buffer_load_dwordx4 v104, s[8:11], s62 offen lds
    buffer_load_dwordx4 v104, s[8:11], s63 offen offset:768 lds
    s_mov_b32 exec_hi, -1
    ds_read_b64_tr_b16 a[16:17], v106 offset:9280
    ds_read_b64_tr_b16 a[18:19], v106 offset:10048
    ds_read_b64_tr_b16 a[20:21], v106 offset:9344
    ds_read_b64_tr_b16 a[22:23], v106 offset:10112
    ds_read_b64_tr_b16 a[12:13], v106 offset:9216
    ds_read_b64_tr_b16 a[14:15], v106 offset:9984
    s_waitcnt lgkmcnt(6)
    v_mfma_f32_32x32x16_bf16 v[32:47], a[4:7], v[64:67], v[32:47]
    v_mfma_f32_32x32x16_bf16 v[48:63], v[64:67], a[8:11], v[48:63]
    v_mfma_f32_32x32x16_bf16 v[16:31], a[0:3], v[64:67], v[16:31]
    ds_read_b64_tr_b16 a[4:5], v106 offset:12352
    ds_read_b64_tr_b16 a[6:7], v106 offset:13120
    ds_read_b64_tr_b16 a[8:9], v106 offset:12416
    ds_read_b64_tr_b16 a[10:11], v106 offset:13184
    ds_read_b64_tr_b16 a[0:1], v106 offset:12288
    ds_read_b64_tr_b16 a[2:3], v106 offset:13056
    s_waitcnt lgkmcnt(6)
    v_mfma_f32_32x32x16_bf16 v[32:47], a[16:19], v[68:71], v[32:47]
    v_mfma_f32_32x32x16_bf16 v[48:63], v[68:71], a[20:23], v[48:63]
    v_mfma_f32_32x32x16_bf16 v[16:31], a[12:15], v[68:71], v[16:31]
    s_waitcnt vmcnt(8)
    ds_read_b128 v[80:83], v100 offset:0
    ds_read_b128 v[84:87], v101 offset:0
    ds_read_b128 v[88:91], v102 offset:0
    ds_read_b128 v[92:95], v103 offset:0
    ds_read_b64_tr_b16 a[16:17], v106 offset:15424
    ds_read_b64_tr_b16 a[18:19], v106 offset:16192
    ds_read_b64_tr_b16 a[20:21], v106 offset:15488
    ds_read_b64_tr_b16 a[22:23], v106 offset:16256
    ds_read_b64_tr_b16 a[12:13], v106 offset:15360
    ds_read_b64_tr_b16 a[14:15], v106 offset:16128
    s_waitcnt lgkmcnt(10)
    v_mfma_f32_32x32x16_bf16 v[32:47], a[4:7], v[72:75], v[32:47]
    v_mfma_f32_32x32x16_bf16 v[48:63], v[72:75], a[8:11], v[48:63]
    v_mfma_f32_32x32x16_bf16 v[16:31], a[0:3], v[72:75], v[16:31]
    s_waitcnt vmcnt(6)
    s_barrier
    ds_read_b64_tr_b16 a[4:5], v106 offset:18496
    ds_read_b64_tr_b16 a[6:7], v106 offset:19264
    ds_read_b64_tr_b16 a[8:9], v106 offset:18560
    ds_read_b64_tr_b16 a[10:11], v106 offset:19328
    ds_read_b64_tr_b16 a[0:1], v106 offset:18432
    ds_read_b64_tr_b16 a[2:3], v106 offset:19200
    s_waitcnt lgkmcnt(6)
    v_mfma_f32_32x32x16_bf16 v[32:47], a[16:19], v[76:79], v[32:47]
    v_mfma_f32_32x32x16_bf16 v[48:63], v[76:79], a[20:23], v[48:63]
    v_mfma_f32_32x32x16_bf16 v[16:31], a[12:15], v[76:79], v[16:31]
    ds_read_b64_tr_b16 a[16:17], v106 offset:21568
    ds_read_b64_tr_b16 a[18:19], v106 offset:22336
    ds_read_b64_tr_b16 a[20:21], v106 offset:21632
    ds_read_b64_tr_b16 a[22:23], v106 offset:22400
    ds_read_b64_tr_b16 a[12:13], v106 offset:21504
    ds_read_b64_tr_b16 a[14:15], v106 offset:22272
    s_waitcnt lgkmcnt(6)
    v_mfma_f32_32x32x16_bf16 v[32:47], a[4:7], v[80:83], v[32:47]
    v_mfma_f32_32x32x16_bf16 v[48:63], v[80:83], a[8:11], v[48:63]
    v_mfma_f32_32x32x16_bf16 v[16:31], a[0:3], v[80:83], v[16:31]
    v_mov_b32 v9, 0
    buffer_load_dwordx2 v[118:119], v9, s[32:35], 0 offen sc1
    ds_read_b64_tr_b16 a[4:5], v106 offset:24640
    ds_read_b64_tr_b16 a[6:7], v106 offset:25408
    ds_read_b64_tr_b16 a[8:9], v106 offset:24704
    ds_read_b64_tr_b16 a[10:11], v106 offset:25472
    ds_read_b64_tr_b16 a[0:1], v106 offset:24576
    ds_read_b64_tr_b16 a[2:3], v106 offset:25344
    s_waitcnt lgkmcnt(6)
    v_mfma_f32_32x32x16_bf16 v[32:47], a[16:19], v[84:87], v[32:47]
    v_mfma_f32_32x32x16_bf16 v[48:63], v[84:87], a[20:23], v[48:63]
    v_mfma_f32_32x32x16_bf16 v[16:31], a[12:15], v[84:87], v[16:31]
    s_waitcnt vmcnt(3)
    ds_read_b128 v[64:67], v100 offset:40960
    ds_read_b128 v[68:71], v101 offset:40960
    ds_read_b128 v[72:75], v102 offset:40960
    ds_read_b128 v[76:79], v103 offset:40960
    ds_read_b64_tr_b16 a[16:17], v106 offset:27712
    ds_read_b64_tr_b16 a[18:19], v106 offset:28480
    ds_read_b64_tr_b16 a[20:21], v106 offset:27776
    ds_read_b64_tr_b16 a[22:23], v106 offset:28544
    ds_read_b64_tr_b16 a[12:13], v106 offset:27648
    ds_read_b64_tr_b16 a[14:15], v106 offset:28416
    s_waitcnt lgkmcnt(10)
    v_mfma_f32_32x32x16_bf16 v[32:47], a[4:7], v[88:91], v[32:47]
    v_mfma_f32_32x32x16_bf16 v[48:63], v[88:91], a[8:11], v[48:63]
    v_mfma_f32_32x32x16_bf16 v[16:31], a[0:3], v[88:91], v[16:31]
    s_waitcnt vmcnt(1)
    s_barrier
    ds_read_b64_tr_b16 a[4:5], v106 offset:30784
    ds_read_b64_tr_b16 a[6:7], v106 offset:31552
    ds_read_b64_tr_b16 a[8:9], v106 offset:30848
    ds_read_b64_tr_b16 a[10:11], v106 offset:31616
    ds_read_b64_tr_b16 a[0:1], v106 offset:30720
    ds_read_b64_tr_b16 a[2:3], v106 offset:31488
    s_waitcnt lgkmcnt(6)
    v_mfma_f32_32x32x16_bf16 v[32:47], a[16:19], v[92:95], v[32:47]
    v_mfma_f32_32x32x16_bf16 v[48:63], v[92:95], a[20:23], v[48:63]
    v_mfma_f32_32x32x16_bf16 v[16:31], a[12:15], v[92:95], v[16:31]
    ds_read_b64_tr_b16 a[16:17], v106 offset:33856
    ds_read_b64_tr_b16 a[18:19], v106 offset:34624
    ds_read_b64_tr_b16 a[20:21], v106 offset:33920
    ds_read_b64_tr_b16 a[22:23], v106 offset:34688
    ds_read_b64_tr_b16 a[12:13], v106 offset:33792
    ds_read_b64_tr_b16 a[14:15], v106 offset:34560
    s_waitcnt lgkmcnt(6)
    v_mfma_f32_32x32x16_bf16 v[32:47], a[4:7], v[64:67], v[32:47]
    v_mfma_f32_32x32x16_bf16 v[48:63], v[64:67], a[8:11], v[48:63]
    v_mfma_f32_32x32x16_bf16 v[16:31], a[0:3], v[64:67], v[16:31]
    ds_read_b64_tr_b16 a[4:5], v106 offset:36928
    ds_read_b64_tr_b16 a[6:7], v106 offset:37696
    ds_read_b64_tr_b16 a[8:9], v106 offset:36992
    ds_read_b64_tr_b16 a[10:11], v106 offset:37760
    ds_read_b64_tr_b16 a[0:1], v106 offset:36864
    ds_read_b64_tr_b16 a[2:3], v106 offset:37632
    s_waitcnt lgkmcnt(6)
    v_mfma_f32_32x32x16_bf16 v[32:47], a[16:19], v[68:71], v[32:47]
    v_mfma_f32_32x32x16_bf16 v[48:63], v[68:71], a[20:23], v[48:63]
    v_mfma_f32_32x32x16_bf16 v[16:31], a[12:15], v[68:71], v[16:31]
    ds_read_b64_tr_b16 a[16:17], v106 offset:40000
    ds_read_b64_tr_b16 a[18:19], v106 offset:40768
    ds_read_b64_tr_b16 a[20:21], v106 offset:40064
    ds_read_b64_tr_b16 a[22:23], v106 offset:40832
    ds_read_b64_tr_b16 a[12:13], v106 offset:39936
    ds_read_b64_tr_b16 a[14:15], v106 offset:40704
    s_waitcnt lgkmcnt(6)
    v_mfma_f32_32x32x16_bf16 v[32:47], a[4:7], v[72:75], v[32:47]
    v_mfma_f32_32x32x16_bf16 v[48:63], v[72:75], a[8:11], v[48:63]
    v_mfma_f32_32x32x16_bf16 v[16:31], a[0:3], v[72:75], v[16:31]
    s_waitcnt lgkmcnt(0)
    v_mfma_f32_32x32x16_bf16 v[32:47], a[16:19], v[76:79], v[32:47]
    v_mfma_f32_32x32x16_bf16 v[48:63], v[76:79], a[20:23], v[48:63]
    v_mfma_f32_32x32x16_bf16 v[16:31], a[12:15], v[76:79], v[16:31]
    s_lshl_b32 s62, s60, 12
    v_add_u32 v4, s65, v3
    v_add_u32 v5, s66, v3
    s_mov_b32 s63, 0x3e8b97f6
    s_nop 5
    v_cvt_pk_bf16_f32 v64, v32, v33
    v_cvt_pk_bf16_f32 v65, v34, v35
    v_cvt_pk_bf16_f32 v66, v36, v37
    v_cvt_pk_bf16_f32 v67, v38, v39
    v_cvt_pk_bf16_f32 v68, v40, v41
    v_cvt_pk_bf16_f32 v69, v42, v43
    v_cvt_pk_bf16_f32 v70, v44, v45
    v_cvt_pk_bf16_f32 v71, v46, v47
    s_mov_b32 exec_lo, 0
    v_mov_b32 v70, 0x3f803f80
    v_mov_b32 v71, 0x00003f80
    s_mov_b32 exec_lo, -1
    buffer_store_dwordx4 v[64:67], v3, s[24:27], s62 offen offset:0 sc1
    buffer_store_dwordx4 v[68:71], v3, s[24:27], s62 offen offset:1024 sc1
    v_mul_f32 v16, s63, v16
    v_mul_f32 v17, s63, v17
    v_mul_f32 v18, s63, v18
    v_mul_f32 v19, s63, v19
    v_mul_f32 v20, s63, v20
    v_mul_f32 v21, s63, v21
    v_mul_f32 v22, s63, v22
    v_mul_f32 v23, s63, v23
    v_mul_f32 v24, s63, v24
    v_mul_f32 v25, s63, v25
    v_mul_f32 v26, s63, v26
    v_mul_f32 v27, s63, v27
    v_mul_f32 v28, s63, v28
    v_mul_f32 v29, s63, v29
    v_mul_f32 v30, s63, v30
    v_mul_f32 v31, s63, v31
    v_cvt_pk_bf16_f32 v80, v16, v17
    v_cvt_pk_bf16_f32 v81, v18, v19
    v_cvt_pk_bf16_f32 v82, v20, v21
    v_cvt_pk_bf16_f32 v83, v22, v23
    v_cvt_pk_bf16_f32 v84, v24, v25
    v_cvt_pk_bf16_f32 v85, v26, v27
    v_cvt_pk_bf16_f32 v86, v28, v29
    v_cvt_pk_bf16_f32 v87, v30, v31
    s_mov_b32 exec_lo, 0
    v_mov_b32 v86, 0
    v_mov_b32 v87, 0
    s_mov_b32 exec_lo, -1
    v_mfma_f32_32x32x16_bf16 v[32:47], v[64:67], v[80:83], 0
    v_mfma_f32_32x32x16_bf16 v[32:47], v[68:71], v[84:87], v[32:47]
    v_cvt_pk_bf16_f32 v72, v48, v49
    v_cvt_pk_bf16_f32 v73, v50, v51
    v_cvt_pk_bf16_f32 v74, v52, v53
    v_cvt_pk_bf16_f32 v75, v54, v55
    v_cvt_pk_bf16_f32 v76, v56, v57
    v_cvt_pk_bf16_f32 v77, v58, v59
    v_cvt_pk_bf16_f32 v78, v60, v61
    v_cvt_pk_bf16_f32 v79, v62, v63
    s_mov_b32 exec_lo, 0x10000000
    s_mov_b32 exec_hi, 0x10000000
    v_mov_b32 v72, 0x3f803f80
    v_mov_b32 v73, 0x3f803f80
    v_mov_b32 v74, 0x3f803f80
    v_mov_b32 v75, 0x3f803f80
    v_mov_b32 v76, 0x3f803f80
    v_mov_b32 v77, 0x3f803f80
    v_mov_b32 v78, 0x3f803f80
    v_mov_b32 v79, 0x3f803f80
    s_mov_b64 exec, -1
    buffer_store_dwordx4 v[72:75], v3, s[24:27], s62 offen offset:2048 sc1
    buffer_store_dwordx4 v[76:79], v3, s[24:27], s62 offen offset:3072 sc1
    ds_write_b128 v4, v[64:67] offset:0
    ds_write_b128 v4, v[68:71] offset:1024
    ds_write_b128 v4, v[72:75] offset:2048
    ds_write_b128 v4, v[76:79] offset:3072
    ds_write_b128 v5, v[80:83]
    v_max3_f32 v4, v32, v33, v34
    v_max3_f32 v6, v35, v36, v37
    v_max3_f32 v4, v4, v38, v39
    v_max3_f32 v6, v6, v40, v41
    v_max3_f32 v4, v4, v42, v43
    v_max3_f32 v6, v6, v44, v45
    v_max3_f32 v4, v4, v46, v47
    v_max_f32 v4, v4, v6
    v_mov_b32 v6, v4
    s_nop 1
    v_permlane32_swap_b32 v4, v6
    s_nop 0
    v_max_f32 v4, v4, v6
    v_sub_f32 v4, 0, v4
    v_and_b32 v6, 0xffff0000, v4
    v_sub_f32 v4, v4, v6
    v_and_b32 v7, 0xffff0000, v4
    v_sub_f32 v4, v4, v7
    v_lshrrev_b32 v6, 16, v6
    s_mov_b32 exec_lo, 0
    v_or_b32 v86, v6, v7
    v_lshrrev_b32 v87, 16, v4
    s_mov_b32 exec_lo, -1
    ds_write_b128 v5, v[84:87] offset:1024
    s_mov_b32 s75, 200000
L_TAG:
    s_waitcnt vmcnt(0)
    v_readfirstlane_b32 s68, v118
    v_readfirstlane_b32 s69, v119
    s_sub_u32 s75, s75, 1
    s_cmp_eq_u32 s68, 0
    s_cbranch_scc1 L_TAGSLOW
L_TAG_OK:
    s_mov_b64 exec, 1
    buffer_store_dwordx2 v[118:119], v115, s[12:15], 0 offen sc1
    s_mov_b64 exec, -1
    s_waitcnt lgkmcnt(0)
    s_barrier
    ds_read_b128 v[8:11], v122
    ds_read_b128 v[12:15], v122 offset:1024
    ds_read_b128 v[16:19], v121
    ds_read_b128 v[20:23], v121 offset:1024
L_PRIME:
    v_add_u32 v112, 126976, v120
    v_add_u32 v113, 0, v120
    ds_read_b128 v[96:99], v112
    ds_read_b128 v[100:103], v112 offset:1024
    ds_read_b128 v[104:107], v112 offset:2048
    s_mov_b32 s71, 0
    s_mov_b32 s72, 126976
    s_mov_b32 s73, 0
    s_mov_b32 s74, 32768
    v_mov_b32 v56, 0
    v_mov_b32 v57, 0
    v_mov_b32 v58, 0
    v_mov_b32 v59, 0
    v_mov_b32 v60, 0
    v_mov_b32 v61, 0
    v_mov_b32 v62, 0
    v_mov_b32 v63, 0
    v_mov_b32 v64, 0
    v_mov_b32 v65, 0
    v_mov_b32 v66, 0
    v_mov_b32 v67, 0
    v_mov_b32 v68, 0
    v_mov_b32 v69, 0
    v_mov_b32 v70, 0
    v_mov_b32 v71, 0
    v_mov_b32 v92, 0
    v_mov_b32 v108, 0
    v_mov_b32 v93, 0
    v_mov_b32 v109, 0
    v_mov_b32 v94, 0
    v_mov_b32 v110, 0
    v_mov_b32 v95, 0
    v_mov_b32 v111, 0
    s_waitcnt lgkmcnt(0)
    v_mfma_f32_32x32x16_bf16 v[24:39], v[96:99], v[8:11], 0
    v_mfma_f32_32x32x16_bf16 v[24:39], v[100:103], v[12:15], v[24:39]
    v_mov_b32 v72, 0
    v_mov_b32 v73, 0
    v_mov_b32 v74, 0
    v_mov_b32 v75, 0
    v_mov_b32 v76, 0
    v_mov_b32 v77, 0
    v_mov_b32 v78, 0
    v_mov_b32 v79, 0
    v_mov_b32 v80, 0
    v_mov_b32 v81, 0
    v_mov_b32 v82, 0
    v_mov_b32 v83, 0
    v_mov_b32 v84, 0
    v_mov_b32 v85, 0
    v_mov_b32 v86, 0
    v_mov_b32 v87, 0
    s_cmp_lg_u32 s77, 0
    s_cbranch_scc1 L_LOOP
    s_barrier
    buffer_load_dwordx2 v[124:125], v115, s[12:15], 0 offen sc1
    s_mov_b32 s49, 0
    s_movk_i32 s50, 0xfe
    v_mfma_f32_32x32x16_bf16 v[40:55], v[96:99], v[16:19], 0
    ds_read_b128 v[96:99], v112 offset:8192
    v_exp_f32 v24, v24
    v_exp_f32 v25, v25
    v_exp_f32 v26, v26
    v_exp_f32 v27, v27
    v_mfma_f32_32x32x16_bf16 v[72:87], v[108:111], v[92:95], v[72:87]
    ds_read_b128 v[108:111], v112 offset:3072
    v_cvt_pk_bf16_f32 v88, v24, v25
    v_cvt_pk_bf16_f32 v89, v26, v27
    v_exp_f32 v28, v28
    v_exp_f32 v29, v29
    v_exp_f32 v30, v30
    v_mfma_f32_32x32x16_bf16 v[40:55], v[100:103], v[20:23], v[40:55]
    ds_read_b128 v[100:103], v112 offset:9216
    v_exp_f32 v31, v31
    v_cvt_pk_bf16_f32 v90, v28, v29
    v_cvt_pk_bf16_f32 v91, v30, v31
    v_exp_f32 v32, v32
    v_exp_f32 v33, v33
    v_exp_f32 v34, v34
    s_waitcnt lgkmcnt(3)
    v_mfma_f32_32x32x16_bf16 v[56:71], v[104:107], v[88:91], v[56:71]
    v_exp_f32 v35, v35
    v_cvt_pk_bf16_f32 v92, v32, v33
    v_cvt_pk_bf16_f32 v93, v34, v35
    buffer_load_dwordx2 v[126:127], v115, s[12:15], 0 offen sc1
    s_mov_b32 m0, s45
    s_add_u32 s59, s46, 0
    buffer_load_dwordx4 v116, s[16:19], s59 offen offset:0 lds
    s_mov_b32 m0, s45
    s_add_u32 s59, s46, -192
    buffer_load_dwordx4 v116, s[16:19], s59 offen offset:1088 lds
    s_mov_b32 m0, s45
    s_add_u32 s59, s46, -384
    buffer_load_dwordx4 v116, s[16:19], s59 offen offset:2176 lds
    s_mov_b32 m0, s45
    s_add_u32 s59, s46, -576
    buffer_load_dwordx4 v116, s[16:19], s59 offen offset:3264 lds
    v_exp_f32 v36, v36
    v_exp_f32 v37, v37
    v_exp_f32 v38, v38
    v_exp_f32 v39, v39
    v_cvt_pk_bf16_f32 v94, v36, v37
    v_cvt_pk_bf16_f32 v95, v38, v39
    s_waitcnt lgkmcnt(0)
    v_mfma_f32_32x32x16_bf16 v[24:39], v[96:99], v[8:11], 0
    v_exp_f32 v40, v40
    v_exp_f32 v41, v41
    v_exp_f32 v42, v42
    v_exp_f32 v43, v43
    v_mfma_f32_32x32x16_bf16 v[56:71], v[108:111], v[92:95], v[56:71]
    v_cvt_pk_bf16_f32 v88, v40, v41
    v_cvt_pk_bf16_f32 v89, v42, v43
    v_exp_f32 v44, v44
    v_exp_f32 v45, v45
    v_exp_f32 v46, v46
    v_mfma_f32_32x32x16_bf16 v[24:39], v[100:103], v[12:15], v[24:39]
    v_exp_f32 v47, v47
    v_cvt_pk_bf16_f32 v90, v44, v45
    v_cvt_pk_bf16_f32 v91, v46, v47
    v_exp_f32 v48, v48
    v_exp_f32 v49, v49
    v_exp_f32 v50, v50
    v_mfma_f32_32x32x16_bf16 v[72:87], v[104:107], v[88:91], v[72:87]
    ds_read_b128 v[104:107], v112 offset:10240
    v_exp_f32 v51, v51
    v_cvt_pk_bf16_f32 v92, v48, v49
    v_cvt_pk_bf16_f32 v93, v50, v51
    s_cmp_lg_u32 s49, 0
    s_cbranch_scc1 L_CK1
    s_waitcnt vmcnt(5)
    v_cmp_eq_u64 vcc, s[68:69], v[124:125]
    s_nop 3
    s_and_b32 s70, vcc_lo, 0xff
    s_sub_u32 s64, 0, s50
    s_and_b32 s64, s64, s50
    s_and_b32 s64, s64, s70
    s_cbranch_scc1 L_GO1
    buffer_load_dwordx2 v[122:123], v115, s[12:15], 0 offen sc1
    s_branch L_CK1
L_GO1:
    s_ff1_i32_b32 s64, s64
    s_bitset0_b32 s50, s64
    s_add_u32 s62, s57, s64
    s_and_b32 s62, s62, 7
    s_add_u32 m0, s73, s76
    s_lshl_b32 s62, s62, 15
    buffer_load_dwordx4 v114, s[24:27], s62 offen offset:0 sc1 lds
    buffer_load_dwordx4 v114, s[24:27], s62 offen offset:1024 sc1 lds
    buffer_load_dwordx4 v114, s[24:27], s62 offen offset:2048 sc1 lds
    buffer_load_dwordx4 v114, s[24:27], s62 offen offset:3072 sc1 lds
    s_mov_b32 s49, 1
L_CK1:
    v_exp_f32 v52, v52
    v_exp_f32 v53, v53
    v_exp_f32 v54, v54
    v_exp_f32 v55, v55
    v_cvt_pk_bf16_f32 v94, v52, v53
    v_cvt_pk_bf16_f32 v95, v54, v55
    s_setprio 0
    v_mfma_f32_32x32x16_bf16 v[40:55], v[96:99], v[16:19], 0
    ds_read_b128 v[96:99], v112 offset:16384
    v_exp_f32 v24, v24
    v_exp_f32 v25, v25
    v_exp_f32 v26, v26
    v_exp_f32 v27, v27
    v_mfma_f32_32x32x16_bf16 v[72:87], v[108:111], v[92:95], v[72:87]
    ds_read_b128 v[108:111], v112 offset:11264
    v_cvt_pk_bf16_f32 v88, v24, v25
    v_cvt_pk_bf16_f32 v89, v26, v27
    v_exp_f32 v28, v28
    v_exp_f32 v29, v29
    v_exp_f32 v30, v30
    v_mfma_f32_32x32x16_bf16 v[40:55], v[100:103], v[20:23], v[40:55]
    ds_read_b128 v[100:103], v112 offset:17408
    v_exp_f32 v31, v31
    v_cvt_pk_bf16_f32 v90, v28, v29
    v_cvt_pk_bf16_f32 v91, v30, v31
    v_exp_f32 v32, v32
    v_exp_f32 v33, v33
    v_exp_f32 v34, v34
    s_waitcnt lgkmcnt(3)
    v_mfma_f32_32x32x16_bf16 v[56:71], v[104:107], v[88:91], v[56:71]
    v_exp_f32 v35, v35
    v_cvt_pk_bf16_f32 v92, v32, v33
    v_cvt_pk_bf16_f32 v93, v34, v35
    s_cmp_lg_u32 s49, 0
    s_cbranch_scc1 L_CK2
    s_waitcnt vmcnt(5)
    v_cmp_eq_u64 vcc, s[68:69], v[126:127]
    s_nop 3
    s_and_b32 s70, vcc_lo, 0xff
    s_sub_u32 s64, 0, s50
    s_and_b32 s64, s64, s50
    s_and_b32 s64, s64, s70
    s_cbranch_scc1 L_GO2
    buffer_load_dwordx2 v[124:125], v115, s[12:15], 0 offen sc1
    s_branch L_CK2
L_GO2:
    s_ff1_i32_b32 s64, s64
    s_bitset0_b32 s50, s64
    s_add_u32 s62, s57, s64
    s_and_b32 s62, s62, 7
    s_add_u32 m0, s73, s76
    s_lshl_b32 s62, s62, 15
    buffer_load_dwordx4 v114, s[24:27], s62 offen offset:0 sc1 lds
    buffer_load_dwordx4 v114, s[24:27], s62 offen offset:1024 sc1 lds
    buffer_load_dwordx4 v114, s[24:27], s62 offen offset:2048 sc1 lds
    buffer_load_dwordx4 v114, s[24:27], s62 offen offset:3072 sc1 lds
    s_mov_b32 s49, 1
L_CK2:
    v_exp_f32 v36, v36
    v_exp_f32 v37, v37
    v_exp_f32 v38, v38
    v_exp_f32 v39, v39
    v_cvt_pk_bf16_f32 v94, v36, v37
    v_cvt_pk_bf16_f32 v95, v38, v39
    s_waitcnt lgkmcnt(0)
    v_mfma_f32_32x32x16_bf16 v[24:39], v[96:99], v[8:11], 0
    v_exp_f32 v40, v40
    v_exp_f32 v41, v41
    v_exp_f32 v42, v42
    v_exp_f32 v43, v43
    v_mfma_f32_32x32x16_bf16 v[56:71], v[108:111], v[92:95], v[56:71]
    v_cvt_pk_bf16_f32 v88, v40, v41
    v_cvt_pk_bf16_f32 v89, v42, v43
    v_exp_f32 v44, v44
    v_exp_f32 v45, v45
    v_exp_f32 v46, v46
    v_mfma_f32_32x32x16_bf16 v[24:39], v[100:103], v[12:15], v[24:39]
    v_exp_f32 v47, v47
    v_cvt_pk_bf16_f32 v90, v44, v45
    v_cvt_pk_bf16_f32 v91, v46, v47
    v_exp_f32 v48, v48
    v_exp_f32 v49, v49
    v_exp_f32 v50, v50
    v_mfma_f32_32x32x16_bf16 v[72:87], v[104:107], v[88:91], v[72:87]
    ds_read_b128 v[104:107], v112 offset:18432
    v_exp_f32 v51, v51
    v_cvt_pk_bf16_f32 v92, v48, v49
    v_cvt_pk_bf16_f32 v93, v50, v51
    s_cmp_lg_u32 s49, 0
    s_cbranch_scc1 L_CK3
    s_waitcnt vmcnt(1)
    v_cmp_eq_u64 vcc, s[68:69], v[122:123]
    s_nop 3
    s_and_b32 s70, vcc_lo, 0xff
    s_sub_u32 s64, 0, s50
    s_and_b32 s64, s64, s50
    s_and_b32 s64, s64, s70
    s_cbranch_scc1 L_GO3
    buffer_load_dwordx2 v[126:127], v115, s[12:15], 0 offen sc1
    s_branch L_CK3
L_GO3:
    s_ff1_i32_b32 s64, s64
    s_bitset0_b32 s50, s64
    s_add_u32 s62, s57, s64
    s_and_b32 s62, s62, 7
    s_add_u32 m0, s73, s76
    s_lshl_b32 s62, s62, 15
    buffer_load_dwordx4 v114, s[24:27], s62 offen offset:0 sc1 lds
    buffer_load_dwordx4 v114, s[24:27], s62 offen offset:1024 sc1 lds
    buffer_load_dwordx4 v114, s[24:27], s62 offen offset:2048 sc1 lds
    buffer_load_dwordx4 v114, s[24:27], s62 offen offset:3072 sc1 lds
    s_mov_b32 s49, 1
L_CK3:
    v_exp_f32 v52, v52
    v_exp_f32 v53, v53
    v_exp_f32 v54, v54
    v_exp_f32 v55, v55
    v_cvt_pk_bf16_f32 v94, v52, v53
    v_cvt_pk_bf16_f32 v95, v54, v55
    v_mfma_f32_32x32x16_bf16 v[40:55], v[96:99], v[16:19], 0
    ds_read_b128 v[96:99], v112 offset:24576
    v_exp_f32 v24, v24
    v_exp_f32 v25, v25
    v_exp_f32 v26, v26
    v_exp_f32 v27, v27
    v_mfma_f32_32x32x16_bf16 v[72:87], v[108:111], v[92:95], v[72:87]
    ds_read_b128 v[108:111], v112 offset:19456
    v_cvt_pk_bf16_f32 v88, v24, v25
    v_cvt_pk_bf16_f32 v89, v26, v27
    v_exp_f32 v28, v28
    v_exp_f32 v29, v29
    v_exp_f32 v30, v30
    v_mfma_f32_32x32x16_bf16 v[40:55], v[100:103], v[20:23], v[40:55]
    ds_read_b128 v[100:103], v112 offset:25600
    v_exp_f32 v31, v31
    v_cvt_pk_bf16_f32 v90, v28, v29
    v_cvt_pk_bf16_f32 v91, v30, v31
    v_exp_f32 v32, v32
    v_exp_f32 v33, v33
    v_exp_f32 v34, v34
    s_waitcnt lgkmcnt(3)
    v_mfma_f32_32x32x16_bf16 v[56:71], v[104:107], v[88:91], v[56:71]
    v_exp_f32 v35, v35
    v_cvt_pk_bf16_f32 v92, v32, v33
    v_cvt_pk_bf16_f32 v93, v34, v35
    s_cmp_lg_u32 s49, 0
    s_cbranch_scc1 L_CK4
    s_waitcnt vmcnt(1)
    v_cmp_eq_u64 vcc, s[68:69], v[124:125]
    s_nop 3
    s_and_b32 s70, vcc_lo, 0xff
    s_sub_u32 s64, 0, s50
    s_and_b32 s64, s64, s50
    s_and_b32 s64, s64, s70
    s_cbranch_scc1 L_GO4
    buffer_load_dwordx2 v[122:123], v115, s[12:15], 0 offen sc1
    s_branch L_CK4
L_GO4:
    s_ff1_i32_b32 s64, s64
    s_bitset0_b32 s50, s64
    s_add_u32 s62, s57, s64
    s_and_b32 s62, s62, 7
    s_add_u32 m0, s73, s76
    s_lshl_b32 s62, s62, 15
    buffer_load_dwordx4 v114, s[24:27], s62 offen offset:0 sc1 lds
    buffer_load_dwordx4 v114, s[24:27], s62 offen offset:1024 sc1 lds
    buffer_load_dwordx4 v114, s[24:27], s62 offen offset:2048 sc1 lds
    buffer_load_dwordx4 v114, s[24:27], s62 offen offset:3072 sc1 lds
    s_mov_b32 s49, 1
L_CK4:
    v_exp_f32 v36, v36
    v_exp_f32 v37, v37
    v_exp_f32 v38, v38
    v_exp_f32 v39, v39
    v_cvt_pk_bf16_f32 v94, v36, v37
    v_cvt_pk_bf16_f32 v95, v38, v39
    s_waitcnt lgkmcnt(0)
    v_mfma_f32_32x32x16_bf16 v[24:39], v[96:99], v[8:11], 0
    v_exp_f32 v40, v40
    v_exp_f32 v41, v41
    v_exp_f32 v42, v42
    v_exp_f32 v43, v43
    v_mfma_f32_32x32x16_bf16 v[56:71], v[108:111], v[92:95], v[56:71]
    v_cvt_pk_bf16_f32 v88, v40, v41
    v_cvt_pk_bf16_f32 v89, v42, v43
    v_exp_f32 v44, v44
    v_exp_f32 v45, v45
    v_exp_f32 v46, v46
    v_mfma_f32_32x32x16_bf16 v[24:39], v[100:103], v[12:15], v[24:39]
    v_exp_f32 v47, v47
    v_cvt_pk_bf16_f32 v90, v44, v45
    v_cvt_pk_bf16_f32 v91, v46, v47
    v_exp_f32 v48, v48
    v_exp_f32 v49, v49
    v_exp_f32 v50, v50
    v_mfma_f32_32x32x16_bf16 v[72:87], v[104:107], v[88:91], v[72:87]
    ds_read_b128 v[104:107], v112 offset:26624
    v_exp_f32 v51, v51
    v_cvt_pk_bf16_f32 v92, v48, v49
    v_cvt_pk_bf16_f32 v93, v50, v51
    s_cmp_lg_u32 s49, 0
    s_cbranch_scc1 L_CK5
    s_waitcnt vmcnt(1)
    v_cmp_eq_u64 vcc, s[68:69], v[126:127]
    s_nop 3
    s_and_b32 s70, vcc_lo, 0xff
    s_mov_b32 s75, 200000
L_P1:
    s_sub_u32 s64, 0, s50
    s_and_b32 s64, s64, s50
    s_and_b32 s64, s64, s70
    s_cbranch_scc1 L_P1_OK
    buffer_load_dwordx2 v[124:125], v115, s[12:15], 0 offen sc1
    s_sub_u32 s75, s75, 1
    s_waitcnt vmcnt(0)
    v_cmp_eq_u64 vcc, s[68:69], v[124:125]
    s_nop 3
    s_and_b32 s70, vcc_lo, 0xff
    s_cmp_lg_u32 s75, 0
    s_cbranch_scc1 L_P1
    s_mov_b32 s64, s50
L_P1_OK:
    s_ff1_i32_b32 s64, s64
    s_bitset0_b32 s50, s64
    s_add_u32 s62, s57, s64
    s_and_b32 s62, s62, 7
    s_add_u32 m0, s73, s76
    s_lshl_b32 s62, s62, 15
    buffer_load_dwordx4 v114, s[24:27], s62 offen offset:0 sc1 lds
    buffer_load_dwordx4 v114, s[24:27], s62 offen offset:1024 sc1 lds
    buffer_load_dwordx4 v114, s[24:27], s62 offen offset:2048 sc1 lds
    buffer_load_dwordx4 v114, s[24:27], s62 offen offset:3072 sc1 lds
    s_mov_b32 s49, 1
L_CK5:
    v_exp_f32 v52, v52
    v_exp_f32 v53, v53
    v_exp_f32 v54, v54
    v_exp_f32 v55, v55
    v_cvt_pk_bf16_f32 v94, v52, v53
    v_cvt_pk_bf16_f32 v95, v54, v55
    s_waitcnt vmcnt(0) lgkmcnt(0)
    s_barrier
    ds_read_b64_tr_b16 a[0:1], v117 offset:0
    ds_read_b64_tr_b16 a[2:3], v117 offset:512
    ds_read_b64_tr_b16 a[4:5], v117 offset:64
    ds_read_b64_tr_b16 a[6:7], v117 offset:576
    s_setprio 1
    v_mfma_f32_32x32x16_bf16 v[40:55], v[96:99], v[16:19], 0
    ds_read_b128 v[96:99], v120 offset:0
    v_exp_f32 v24, v24
    v_exp_f32 v25, v25
    v_exp_f32 v26, v26
    v_exp_f32 v27, v27
    v_mfma_f32_32x32x16_bf16 v[72:87], v[108:111], v[92:95], v[72:87]
    ds_read_b128 v[108:111], v112 offset:27648
    v_cvt_pk_bf16_f32 v88, v24, v25
    v_cvt_pk_bf16_f32 v89, v26, v27
    s_bitcmp1_b32 s70, 2
    s_cbranch_scc0 L_SLOW0
L_FAST0:
    s_add_u32 s51, s57, 2
    s_and_b32 s51, s51, 7
    s_lshl_b32 s51, s51, 15
    s_add_u32 m0, s76, 32768
    s_nop 0
    buffer_load_dwordx4 v114, s[24:27], s51 offen offset:0 sc1 lds
    v_exp_f32 v28, v28
    v_exp_f32 v29, v29
    v_exp_f32 v30, v30
    v_mfma_f32_32x32x16_bf16 v[40:55], v[100:103], v[20:23], v[40:55]
    ds_read_b128 v[100:103], v120 offset:1024
    v_exp_f32 v31, v31
    v_cvt_pk_bf16_f32 v90, v28, v29
    v_cvt_pk_bf16_f32 v91, v30, v31
    v_exp_f32 v32, v32
    v_exp_f32 v33, v33
    v_exp_f32 v34, v34
    s_waitcnt lgkmcnt(3)
    v_mfma_f32_32x32x16_bf16 v[56:71], v[104:107], v[88:91], v[56:71]
    v_exp_f32 v35, v35
    v_cvt_pk_bf16_f32 v92, v32, v33
    v_cvt_pk_bf16_f32 v93, v34, v35
    s_add_u32 m0, s76, 32768
    s_nop 0
    buffer_load_dwordx4 v114, s[24:27], s51 offen offset:1024 sc1 lds
    v_exp_f32 v36, v36
    v_exp_f32 v37, v37
    v_exp_f32 v38, v38
    v_exp_f32 v39, v39
    v_cvt_pk_bf16_f32 v94, v36, v37
    v_cvt_pk_bf16_f32 v95, v38, v39
    s_waitcnt lgkmcnt(0)
    v_mfma_f32_32x32x16_bf16 v[24:39], v[96:99], v[8:11], 0
    v_exp_f32 v40, v40
    v_exp_f32 v41, v41
    v_exp_f32 v42, v42
    v_exp_f32 v43, v43
    v_mfma_f32_32x32x16_bf16 v[56:71], v[108:111], v[92:95], v[56:71]
    v_cvt_pk_bf16_f32 v88, v40, v41
    v_cvt_pk_bf16_f32 v89, v42, v43
    s_add_u32 m0, s76, 32768
    s_nop 0
    buffer_load_dwordx4 v114, s[24:27], s51 offen offset:2048 sc1 lds
    v_exp_f32 v44, v44
    v_exp_f32 v45, v45
    v_exp_f32 v46, v46
    v_mfma_f32_32x32x16_bf16 v[24:39], v[100:103], v[12:15], v[24:39]
    v_exp_f32 v47, v47
    v_cvt_pk_bf16_f32 v90, v44, v45
    v_cvt_pk_bf16_f32 v91, v46, v47
    ds_read_b64_tr_b16 a[8:9], v117 offset:128
    ds_read_b64_tr_b16 a[10:11], v117 offset:640
    ds_read_b64_tr_b16 a[12:13], v117 offset:192
    ds_read_b64_tr_b16 a[14:15], v117 offset:704
    v_exp_f32 v48, v48
    v_exp_f32 v49, v49
    v_exp_f32 v50, v50
    v_mfma_f32_32x32x16_bf16 v[72:87], v[104:107], v[88:91], v[72:87]
    ds_read_b128 v[104:107], v120 offset:2048
    v_exp_f32 v51, v51
    v_cvt_pk_bf16_f32 v92, v48, v49
    v_cvt_pk_bf16_f32 v93, v50, v51
    s_add_u32 m0, s76, 32768
    s_nop 0
    buffer_load_dwordx4 v114, s[24:27], s51 offen offset:3072 sc1 lds
    v_exp_f32 v52, v52
    v_exp_f32 v53, v53
    v_exp_f32 v54, v54
    v_exp_f32 v55, v55
    v_cvt_pk_bf16_f32 v94, v52, v53
    v_cvt_pk_bf16_f32 v95, v54, v55
    v_mfma_f32_32x32x16_bf16 v[40:55], v[96:99], v[16:19], 0
    ds_read_b128 v[96:99], v120 offset:8192
    v_exp_f32 v24, v24
    v_exp_f32 v25, v25
    v_exp_f32 v26, v26
    v_exp_f32 v27, v27
    v_mfma_f32_32x32x16_bf16 v[72:87], v[108:111], v[92:95], v[72:87]
    ds_read_b128 v[108:111], v120 offset:3072
    v_cvt_pk_bf16_f32 v88, v24, v25
    v_cvt_pk_bf16_f32 v89, v26, v27
    v_exp_f32 v28, v28
    v_exp_f32 v29, v29
    v_exp_f32 v30, v30
    v_mfma_f32_32x32x16_bf16 v[40:55], v[100:103], v[20:23], v[40:55]
    ds_read_b128 v[100:103], v120 offset:9216
    v_exp_f32 v31, v31
    v_cvt_pk_bf16_f32 v90, v28, v29
    v_cvt_pk_bf16_f32 v91, v30, v31
    v_exp_f32 v32, v32
    v_exp_f32 v33, v33
    v_exp_f32 v34, v34
    s_waitcnt lgkmcnt(3)
    v_mfma_f32_32x32x16_bf16 v[56:71], v[104:107], v[88:91], v[56:71]
    v_exp_f32 v35, v35
    v_cvt_pk_bf16_f32 v92, v32, v33
    v_cvt_pk_bf16_f32 v93, v34, v35
    s_mov_b32 m0, s45
    s_add_u32 s59, s46, 14336
    buffer_load_dwordx4 v116, s[16:19], s59 offen offset:0 lds
    v_exp_f32 v36, v36
    v_exp_f32 v37, v37
    v_exp_f32 v38, v38
    v_exp_f32 v39, v39
    v_cvt_pk_bf16_f32 v94, v36, v37
    v_cvt_pk_bf16_f32 v95, v38, v39
    s_waitcnt lgkmcnt(0)
    v_mfma_f32_32x32x16_bf16 v[24:39], v[96:99], v[8:11], 0
    v_exp_f32 v40, v40
    v_exp_f32 v41, v41
    v_exp_f32 v42, v42
    v_exp_f32 v43, v43
    v_mfma_f32_32x32x16_bf16 v[56:71], v[108:111], v[92:95], v[56:71]
    v_cvt_pk_bf16_f32 v88, v40, v41
    v_cvt_pk_bf16_f32 v89, v42, v43
    v_exp_f32 v44, v44
    v_exp_f32 v45, v45
    v_exp_f32 v46, v46
    v_mfma_f32_32x32x16_bf16 v[24:39], v[100:103], v[12:15], v[24:39]
    v_exp_f32 v47, v47
    v_cvt_pk_bf16_f32 v90, v44, v45
    v_cvt_pk_bf16_f32 v91, v46, v47
    s_mov_b32 m0, s45
    s_add_u32 s59, s46, 14144
    buffer_load_dwordx4 v116, s[16:19], s59 offen offset:1088 lds
    v_exp_f32 v48, v48
    v_exp_f32 v49, v49
    v_exp_f32 v50, v50
    v_mfma_f32_32x32x16_bf16 v[72:87], v[104:107], v[88:91], v[72:87]
    ds_read_b128 v[104:107], v120 offset:10240
    v_exp_f32 v51, v51
    v_cvt_pk_bf16_f32 v92, v48, v49
    v_cvt_pk_bf16_f32 v93, v50, v51
    s_mov_b32 m0, s45
    s_add_u32 s59, s46, 13952
    buffer_load_dwordx4 v116, s[16:19], s59 offen offset:2176 lds
    v_exp_f32 v52, v52
    v_exp_f32 v53, v53
    v_exp_f32 v54, v54
    v_exp_f32 v55, v55
    v_cvt_pk_bf16_f32 v94, v52, v53
    v_cvt_pk_bf16_f32 v95, v54, v55
    s_setprio 0
    v_mfma_f32_32x32x16_bf16 v[40:55], v[96:99], v[16:19], 0
    ds_read_b128 v[96:99], v120 offset:16384
    v_exp_f32 v24, v24
    v_exp_f32 v25, v25
    v_exp_f32 v26, v26
    v_exp_f32 v27, v27
    v_mfma_f32_32x32x16_bf16 v[72:87], v[108:111], v[92:95], v[72:87]
    ds_read_b128 v[108:111], v120 offset:11264
    v_cvt_pk_bf16_f32 v88, v24, v25
    v_cvt_pk_bf16_f32 v89, v26, v27
    v_exp_f32 v28, v28
    v_exp_f32 v29, v29
    v_exp_f32 v30, v30
    v_mfma_f32_32x32x16_bf16 v[40:55], v[100:103], v[20:23], v[40:55]
    ds_read_b128 v[100:103], v120 offset:17408
    v_exp_f32 v31, v31
    v_cvt_pk_bf16_f32 v90, v28, v29
    v_cvt_pk_bf16_f32 v91, v30, v31
    s_mov_b32 m0, s45
    s_add_u32 s59, s46, 13760
    buffer_load_dwordx4 v116, s[16:19], s59 offen offset:3264 lds
    v_exp_f32 v32, v32
    v_exp_f32 v33, v33
    v_exp_f32 v34, v34
    s_waitcnt lgkmcnt(3)
    v_mfma_f32_32x32x16_bf16 v[56:71], v[104:107], v[88:91], v[56:71]
    v_exp_f32 v35, v35
    v_cvt_pk_bf16_f32 v92, v32, v33
    v_cvt_pk_bf16_f32 v93, v34, v35
    v_exp_f32 v36, v36
    v_exp_f32 v37, v37
    v_exp_f32 v38, v38
    v_exp_f32 v39, v39
    v_cvt_pk_bf16_f32 v94, v36, v37
    v_cvt_pk_bf16_f32 v95, v38, v39
    s_waitcnt lgkmcnt(0)
    v_mfma_f32_32x32x16_bf16 v[24:39], v[96:99], v[8:11], 0
    v_exp_f32 v40, v40
    v_exp_f32 v41, v41
    v_exp_f32 v42, v42
    v_exp_f32 v43, v43
    v_mfma_f32_32x32x16_bf16 v[56:71], v[108:111], v[92:95], v[56:71]
    v_cvt_pk_bf16_f32 v88, v40, v41
    v_cvt_pk_bf16_f32 v89, v42, v43
    v_exp_f32 v44, v44
    v_exp_f32 v45, v45
    v_exp_f32 v46, v46
    v_mfma_f32_32x32x16_bf16 v[24:39], v[100:103], v[12:15], v[24:39]
    v_exp_f32 v47, v47
    v_cvt_pk_bf16_f32 v90, v44, v45
    v_cvt_pk_bf16_f32 v91, v46, v47
    v_exp_f32 v48, v48
    v_exp_f32 v49, v49
    v_exp_f32 v50, v50
    v_mfma_f32_32x32x16_bf16 v[72:87], v[104:107], v[88:91], v[72:87]
    ds_read_b128 v[104:107], v120 offset:18432
    v_exp_f32 v51, v51
    v_cvt_pk_bf16_f32 v92, v48, v49
    v_cvt_pk_bf16_f32 v93, v50, v51
    v_exp_f32 v52, v52
    v_exp_f32 v53, v53
    v_exp_f32 v54, v54
    v_exp_f32 v55, v55
    v_cvt_pk_bf16_f32 v94, v52, v53
    v_cvt_pk_bf16_f32 v95, v54, v55
    v_mfma_f32_32x32x16_bf16 v[40:55], v[96:99], v[16:19], 0
    ds_read_b128 v[96:99], v120 offset:24576
    v_exp_f32 v24, v24
    v_exp_f32 v25, v25
    v_exp_f32 v26, v26
    v_exp_f32 v27, v27
    v_mfma_f32_32x32x16_bf16 v[72:87], v[108:111], v[92:95], v[72:87]
    ds_read_b128 v[108:111], v120 offset:19456
    v_cvt_pk_bf16_f32 v88, v24, v25
    v_cvt_pk_bf16_f32 v89, v26, v27
    v_exp_f32 v28, v28
    v_exp_f32 v29, v29
    v_exp_f32 v30, v30
    v_mfma_f32_32x32x16_bf16 v[40:55], v[100:103], v[20:23], v[40:55]
    ds_read_b128 v[100:103], v120 offset:25600
    v_exp_f32 v31, v31
    v_cvt_pk_bf16_f32 v90, v28, v29
    v_cvt_pk_bf16_f32 v91, v30, v31
    v_exp_f32 v32, v32
    v_exp_f32 v33, v33
    v_exp_f32 v34, v34
    s_waitcnt lgkmcnt(3)
    v_mfma_f32_32x32x16_bf16 v[56:71], v[104:107], v[88:91], v[56:71]
    v_exp_f32 v35, v35
    v_cvt_pk_bf16_f32 v92, v32, v33
    v_cvt_pk_bf16_f32 v93, v34, v35
    v_exp_f32 v36, v36
    v_exp_f32 v37, v37
    v_exp_f32 v38, v38
    v_exp_f32 v39, v39
    v_cvt_pk_bf16_f32 v94, v36, v37
    v_cvt_pk_bf16_f32 v95, v38, v39
    s_waitcnt lgkmcnt(0)
    v_mfma_f32_32x32x16_bf16 v[24:39], v[96:99], v[8:11], 0
    v_exp_f32 v40, v40
    v_exp_f32 v41, v41
    v_exp_f32 v42, v42
    v_exp_f32 v43, v43
    v_mfma_f32_32x32x16_bf16 v[56:71], v[108:111], v[92:95], v[56:71]
    v_cvt_pk_bf16_f32 v88, v40, v41
    v_cvt_pk_bf16_f32 v89, v42, v43
    v_exp_f32 v44, v44
    v_exp_f32 v45, v45
    v_exp_f32 v46, v46
    v_mfma_f32_32x32x16_bf16 v[24:39], v[100:103], v[12:15], v[24:39]
    v_exp_f32 v47, v47
    v_cvt_pk_bf16_f32 v90, v44, v45
    v_cvt_pk_bf16_f32 v91, v46, v47
    v_exp_f32 v48, v48
    v_exp_f32 v49, v49
    v_exp_f32 v50, v50
    v_mfma_f32_32x32x16_bf16 v[72:87], v[104:107], v[88:91], v[72:87]
    ds_read_b128 v[104:107], v120 offset:26624
    v_exp_f32 v51, v51
    v_cvt_pk_bf16_f32 v92, v48, v49
    v_cvt_pk_bf16_f32 v93, v50, v51
    v_exp_f32 v52, v52
    v_exp_f32 v53, v53
    v_exp_f32 v54, v54
    v_exp_f32 v55, v55
    v_cvt_pk_bf16_f32 v94, v52, v53
    v_cvt_pk_bf16_f32 v95, v54, v55
    s_waitcnt vmcnt(0) lgkmcnt(0)
    s_barrier
    ds_read_b64_tr_b16 a[16:17], v117 offset:0
    ds_read_b64_tr_b16 a[18:19], v117 offset:512
    ds_read_b64_tr_b16 a[20:21], v117 offset:64
    ds_read_b64_tr_b16 a[22:23], v117 offset:576
    s_setprio 1
    v_mfma_f32_32x32x16_bf16 v[40:55], v[96:99], v[16:19], 0
    ds_read_b128 v[96:99], v120 offset:32768
    v_exp_f32 v24, v24
    v_exp_f32 v25, v25
    v_exp_f32 v26, v26
    v_exp_f32 v27, v27
    v_mfma_f32_32x32x16_bf16 v[72:87], v[108:111], v[92:95], v[72:87]
    ds_read_b128 v[108:111], v120 offset:27648
    v_cvt_pk_bf16_f32 v88, v24, v25
    v_cvt_pk_bf16_f32 v89, v26, v27
    s_bitcmp1_b32 s70, 3
    s_cbranch_scc0 L_SLOW1
L_FAST1:
    s_add_u32 s51, s57, 3
    s_and_b32 s51, s51, 7
    s_lshl_b32 s51, s51, 15
    s_add_u32 m0, s76, 126976
    s_nop 0
    buffer_load_dwordx4 v114, s[24:27], s51 offen offset:0 sc1 lds
    v_exp_f32 v28, v28
    v_exp_f32 v29, v29
    v_exp_f32 v30, v30
    v_mfma_f32_32x32x16_bf16 v[40:55], v[100:103], v[20:23], v[40:55]
    ds_read_b128 v[100:103], v120 offset:33792
    v_exp_f32 v31, v31
    v_cvt_pk_bf16_f32 v90, v28, v29
    v_cvt_pk_bf16_f32 v91, v30, v31
    v_exp_f32 v32, v32
    v_exp_f32 v33, v33
    v_exp_f32 v34, v34
    s_waitcnt lgkmcnt(3)
    v_mfma_f32_32x32x16_bf16 v[56:71], v[104:107], v[88:91], v[56:71]
    v_exp_f32 v35, v35
    v_cvt_pk_bf16_f32 v92, v32, v33
    v_cvt_pk_bf16_f32 v93, v34, v35
    s_add_u32 m0, s76, 126976
    s_nop 0
    buffer_load_dwordx4 v114, s[24:27], s51 offen offset:1024 sc1 lds
    v_exp_f32 v36, v36
    v_exp_f32 v37, v37
    v_exp_f32 v38, v38
    v_exp_f32 v39, v39
    v_cvt_pk_bf16_f32 v94, v36, v37
    v_cvt_pk_bf16_f32 v95, v38, v39
    s_waitcnt lgkmcnt(0)
    v_mfma_f32_32x32x16_bf16 v[24:39], v[96:99], v[8:11], 0
    v_exp_f32 v40, v40
    v_exp_f32 v41, v41
    v_exp_f32 v42, v42
    v_exp_f32 v43, v43
    v_mfma_f32_32x32x16_bf16 v[56:71], v[108:111], v[92:95], v[56:71]
    v_cvt_pk_bf16_f32 v88, v40, v41
    v_cvt_pk_bf16_f32 v89, v42, v43
    s_add_u32 m0, s76, 126976
    s_nop 0
    buffer_load_dwordx4 v114, s[24:27], s51 offen offset:2048 sc1 lds
    v_exp_f32 v44, v44
    v_exp_f32 v45, v45
    v_exp_f32 v46, v46
    v_mfma_f32_32x32x16_bf16 v[24:39], v[100:103], v[12:15], v[24:39]
    v_exp_f32 v47, v47
    v_cvt_pk_bf16_f32 v90, v44, v45
    v_cvt_pk_bf16_f32 v91, v46, v47
    ds_read_b64_tr_b16 a[24:25], v117 offset:128
    ds_read_b64_tr_b16 a[26:27], v117 offset:640
    ds_read_b64_tr_b16 a[28:29], v117 offset:192
    ds_read_b64_tr_b16 a[30:31], v117 offset:704
    v_exp_f32 v48, v48
    v_exp_f32 v49, v49
    v_exp_f32 v50, v50
    v_mfma_f32_32x32x16_bf16 v[72:87], v[104:107], v[88:91], v[72:87]
    ds_read_b128 v[104:107], v120 offset:34816
    v_exp_f32 v51, v51
    v_cvt_pk_bf16_f32 v92, v48, v49
    v_cvt_pk_bf16_f32 v93, v50, v51
    s_add_u32 m0, s76, 126976
    s_nop 0
    buffer_load_dwordx4 v114, s[24:27], s51 offen offset:3072 sc1 lds
    v_exp_f32 v52, v52
    v_exp_f32 v53, v53
    v_exp_f32 v54, v54
    v_exp_f32 v55, v55
    v_cvt_pk_bf16_f32 v94, v52, v53
    v_cvt_pk_bf16_f32 v95, v54, v55
    v_mfma_f32_32x32x16_bf16 v[40:55], v[96:99], v[16:19], 0
    ds_read_b128 v[96:99], v120 offset:40960
    v_exp_f32 v24, v24
    v_exp_f32 v25, v25
    v_exp_f32 v26, v26
    v_exp_f32 v27, v27
    v_mfma_f32_32x32x16_bf16 v[72:87], v[108:111], v[92:95], v[72:87]
    ds_read_b128 v[108:111], v120 offset:35840
    v_cvt_pk_bf16_f32 v88, v24, v25
    v_cvt_pk_bf16_f32 v89, v26, v27
    v_exp_f32 v28, v28
    v_exp_f32 v29, v29
    v_exp_f32 v30, v30
    v_mfma_f32_32x32x16_bf16 v[40:55], v[100:103], v[20:23], v[40:55]
    ds_read_b128 v[100:103], v120 offset:41984
    v_exp_f32 v31, v31
    v_cvt_pk_bf16_f32 v90, v28, v29
    v_cvt_pk_bf16_f32 v91, v30, v31
    v_exp_f32 v32, v32
    v_exp_f32 v33, v33
    v_exp_f32 v34, v34
    s_waitcnt lgkmcnt(3)
    v_mfma_f32_32x32x16_bf16 v[56:71], v[104:107], v[88:91], v[56:71]
    v_exp_f32 v35, v35
    v_cvt_pk_bf16_f32 v92, v32, v33
    v_cvt_pk_bf16_f32 v93, v34, v35
    s_mov_b32 m0, s45
    s_add_u32 s59, s46, 25088
    buffer_load_dwordx4 v116, s[16:19], s59 offen offset:0 lds
    v_exp_f32 v36, v36
    v_exp_f32 v37, v37
    v_exp_f32 v38, v38
    v_exp_f32 v39, v39
    v_cvt_pk_bf16_f32 v94, v36, v37
    v_cvt_pk_bf16_f32 v95, v38, v39
    s_waitcnt lgkmcnt(0)
    v_mfma_f32_32x32x16_bf16 v[24:39], v[96:99], v[8:11], 0
    v_exp_f32 v40, v40
    v_exp_f32 v41, v41
    v_exp_f32 v42, v42
    v_exp_f32 v43, v43
    v_mfma_f32_32x32x16_bf16 v[56:71], v[108:111], v[92:95], v[56:71]
    v_cvt_pk_bf16_f32 v88, v40, v41
    v_cvt_pk_bf16_f32 v89, v42, v43
    v_exp_f32 v44, v44
    v_exp_f32 v45, v45
    v_exp_f32 v46, v46
    v_mfma_f32_32x32x16_bf16 v[24:39], v[100:103], v[12:15], v[24:39]
    v_exp_f32 v47, v47
    v_cvt_pk_bf16_f32 v90, v44, v45
    v_cvt_pk_bf16_f32 v91, v46, v47
    s_mov_b32 m0, s45
    s_add_u32 s59, s46, 24896
    buffer_load_dwordx4 v116, s[16:19], s59 offen offset:1088 lds
    v_exp_f32 v48, v48
    v_exp_f32 v49, v49
    v_exp_f32 v50, v50
    v_mfma_f32_32x32x16_bf16 v[72:87], v[104:107], v[88:91], v[72:87]
    ds_read_b128 v[104:107], v120 offset:43008
    v_exp_f32 v51, v51
    v_cvt_pk_bf16_f32 v92, v48, v49
    v_cvt_pk_bf16_f32 v93, v50, v51
    s_mov_b32 m0, s45
    s_add_u32 s59, s46, 24704
    buffer_load_dwordx4 v116, s[16:19], s59 offen offset:2176 lds
    v_exp_f32 v52, v52
    v_exp_f32 v53, v53
    v_exp_f32 v54, v54
    v_exp_f32 v55, v55
    v_cvt_pk_bf16_f32 v94, v52, v53
    v_cvt_pk_bf16_f32 v95, v54, v55
    s_setprio 0
    v_mfma_f32_32x32x16_bf16 v[40:55], v[96:99], v[16:19], 0
    ds_read_b128 v[96:99], v120 offset:49152
    v_exp_f32 v24, v24
    v_exp_f32 v25, v25
    v_exp_f32 v26, v26
    v_exp_f32 v27, v27
    v_mfma_f32_32x32x16_bf16 v[72:87], v[108:111], v[92:95], v[72:87]
    ds_read_b128 v[108:111], v120 offset:44032
    v_cvt_pk_bf16_f32 v88, v24, v25
    v_cvt_pk_bf16_f32 v89, v26, v27
    v_exp_f32 v28, v28
    v_exp_f32 v29, v29
    v_exp_f32 v30, v30
    v_mfma_f32_32x32x16_bf16 v[40:55], v[100:103], v[20:23], v[40:55]
    ds_read_b128 v[100:103], v120 offset:50176
    v_exp_f32 v31, v31
    v_cvt_pk_bf16_f32 v90, v28, v29
    v_cvt_pk_bf16_f32 v91, v30, v31
    s_mov_b32 m0, s45
    s_add_u32 s59, s46, 24512
    buffer_load_dwordx4 v116, s[16:19], s59 offen offset:3264 lds
    v_exp_f32 v32, v32
    v_exp_f32 v33, v33
    v_exp_f32 v34, v34
    s_waitcnt lgkmcnt(3)
    v_mfma_f32_32x32x16_bf16 v[56:71], v[104:107], v[88:91], v[56:71]
    v_exp_f32 v35, v35
    v_cvt_pk_bf16_f32 v92, v32, v33
    v_cvt_pk_bf16_f32 v93, v34, v35
    v_exp_f32 v36, v36
    v_exp_f32 v37, v37
    v_exp_f32 v38, v38
    v_exp_f32 v39, v39
    v_cvt_pk_bf16_f32 v94, v36, v37
    v_cvt_pk_bf16_f32 v95, v38, v39
    s_waitcnt lgkmcnt(0)
    v_mfma_f32_32x32x16_bf16 v[24:39], v[96:99], v[8:11], 0
    v_exp_f32 v40, v40
    v_exp_f32 v41, v41
    v_exp_f32 v42, v42
    v_exp_f32 v43, v43
    v_mfma_f32_32x32x16_bf16 v[56:71], v[108:111], v[92:95], v[56:71]
    v_cvt_pk_bf16_f32 v88, v40, v41
    v_cvt_pk_bf16_f32 v89, v42, v43
    v_exp_f32 v44, v44
    v_exp_f32 v45, v45
    v_exp_f32 v46, v46
    v_mfma_f32_32x32x16_bf16 v[24:39], v[100:103], v[12:15], v[24:39]
    v_exp_f32 v47, v47
    v_cvt_pk_bf16_f32 v90, v44, v45
    v_cvt_pk_bf16_f32 v91, v46, v47
    v_exp_f32 v48, v48
    v_exp_f32 v49, v49
    v_exp_f32 v50, v50
    v_mfma_f32_32x32x16_bf16 v[72:87], v[104:107], v[88:91], v[72:87]
    ds_read_b128 v[104:107], v120 offset:51200
    v_exp_f32 v51, v51
    v_cvt_pk_bf16_f32 v92, v48, v49
    v_cvt_pk_bf16_f32 v93, v50, v51
    v_exp_f32 v52, v52
    v_exp_f32 v53, v53
    v_exp_f32 v54, v54
    v_exp_f32 v55, v55
    v_cvt_pk_bf16_f32 v94, v52, v53
    v_cvt_pk_bf16_f32 v95, v54, v55
    v_mfma_f32_32x32x16_bf16 v[40:55], v[96:99], v[16:19], 0
    ds_read_b128 v[96:99], v120 offset:57344
    v_exp_f32 v24, v24
    v_exp_f32 v25, v25
    v_exp_f32 v26, v26
    v_exp_f32 v27, v27
    v_mfma_f32_32x32x16_bf16 v[72:87], v[108:111], v[92:95], v[72:87]
    ds_read_b128 v[108:111], v120 offset:52224
    v_cvt_pk_bf16_f32 v88, v24, v25
    v_cvt_pk_bf16_f32 v89, v26, v27
    v_exp_f32 v28, v28
    v_exp_f32 v29, v29
    v_exp_f32 v30, v30
    v_mfma_f32_32x32x16_bf16 v[40:55], v[100:103], v[20:23], v[40:55]
    ds_read_b128 v[100:103], v120 offset:58368
    v_exp_f32 v31, v31
    v_cvt_pk_bf16_f32 v90, v28, v29
    v_cvt_pk_bf16_f32 v91, v30, v31
    v_exp_f32 v32, v32
    v_exp_f32 v33, v33
    v_exp_f32 v34, v34
    s_waitcnt lgkmcnt(3)
    v_mfma_f32_32x32x16_bf16 v[56:71], v[104:107], v[88:91], v[56:71]
    v_exp_f32 v35, v35
    v_cvt_pk_bf16_f32 v92, v32, v33
    v_cvt_pk_bf16_f32 v93, v34, v35
    v_exp_f32 v36, v36
    v_exp_f32 v37, v37
    v_exp_f32 v38, v38
    v_exp_f32 v39, v39
    v_cvt_pk_bf16_f32 v94, v36, v37
    v_cvt_pk_bf16_f32 v95, v38, v39
    s_waitcnt lgkmcnt(0)
    v_mfma_f32_32x32x16_bf16 v[24:39], v[96:99], v[8:11], 0
    v_exp_f32 v40, v40
    v_exp_f32 v41, v41
    v_exp_f32 v42, v42
    v_exp_f32 v43, v43
    v_mfma_f32_32x32x16_bf16 v[56:71], v[108:111], v[92:95], v[56:71]
    v_cvt_pk_bf16_f32 v88, v40, v41
    v_cvt_pk_bf16_f32 v89, v42, v43
    v_exp_f32 v44, v44
    v_exp_f32 v45, v45
    v_exp_f32 v46, v46
    v_mfma_f32_32x32x16_bf16 v[24:39], v[100:103], v[12:15], v[24:39]
    v_exp_f32 v47, v47
    v_cvt_pk_bf16_f32 v90, v44, v45
    v_cvt_pk_bf16_f32 v91, v46, v47
    v_exp_f32 v48, v48
    v_exp_f32 v49, v49
    v_exp_f32 v50, v50
    v_mfma_f32_32x32x16_bf16 v[72:87], v[104:107], v[88:91], v[72:87]
    ds_read_b128 v[104:107], v120 offset:59392
    v_exp_f32 v51, v51
    v_cvt_pk_bf16_f32 v92, v48, v49
    v_cvt_pk_bf16_f32 v93, v50, v51
    v_exp_f32 v52, v52
    v_exp_f32 v53, v53
    v_exp_f32 v54, v54
    v_exp_f32 v55, v55
    v_cvt_pk_bf16_f32 v94, v52, v53
    v_cvt_pk_bf16_f32 v95, v54, v55
    s_waitcnt vmcnt(0) lgkmcnt(0)
    s_barrier
    ds_read_b64_tr_b16 a[32:33], v117 offset:0
    ds_read_b64_tr_b16 a[34:35], v117 offset:512
    ds_read_b64_tr_b16 a[36:37], v117 offset:64
    ds_read_b64_tr_b16 a[38:39], v117 offset:576
    s_setprio 1
    v_mfma_f32_32x32x16_bf16 v[40:55], v[96:99], v[16:19], 0
    ds_read_b128 v[96:99], v112 offset:0
    v_exp_f32 v24, v24
    v_exp_f32 v25, v25
    v_exp_f32 v26, v26
    v_exp_f32 v27, v27
    v_mfma_f32_32x32x16_bf16 v[72:87], v[108:111], v[92:95], v[72:87]
    ds_read_b128 v[108:111], v120 offset:60416
    v_cvt_pk_bf16_f32 v88, v24, v25
    v_cvt_pk_bf16_f32 v89, v26, v27
    s_bitcmp1_b32 s70, 4
    s_cbranch_scc0 L_SLOW2
L_FAST2:
    s_add_u32 s51, s57, 4
    s_and_b32 s51, s51, 7
    s_lshl_b32 s51, s51, 15
    s_add_u32 m0, s76, 0
    s_nop 0
    buffer_load_dwordx4 v114, s[24:27], s51 offen offset:0 sc1 lds
    v_exp_f32 v28, v28
    v_exp_f32 v29, v29
    v_exp_f32 v30, v30
    v_mfma_f32_32x32x16_bf16 v[40:55], v[100:103], v[20:23], v[40:55]
    ds_read_b128 v[100:103], v112 offset:1024
    v_exp_f32 v31, v31
    v_cvt_pk_bf16_f32 v90, v28, v29
    v_cvt_pk_bf16_f32 v91, v30, v31
    v_exp_f32 v32, v32
    v_exp_f32 v33, v33
    v_exp_f32 v34, v34
    s_waitcnt lgkmcnt(3)
    v_mfma_f32_32x32x16_bf16 v[56:71], v[104:107], v[88:91], v[56:71]
    v_exp_f32 v35, v35
    v_cvt_pk_bf16_f32 v92, v32, v33
    v_cvt_pk_bf16_f32 v93, v34, v35
    s_add_u32 m0, s76, 0
    s_nop 0
    buffer_load_dwordx4 v114, s[24:27], s51 offen offset:1024 sc1 lds
    v_exp_f32 v36, v36
    v_exp_f32 v37, v37
    v_exp_f32 v38, v38
    v_exp_f32 v39, v39
    v_cvt_pk_bf16_f32 v94, v36, v37
    v_cvt_pk_bf16_f32 v95, v38, v39
    s_waitcnt lgkmcnt(0)
    v_mfma_f32_32x32x16_bf16 v[24:39], v[96:99], v[8:11], 0
    v_exp_f32 v40, v40
    v_exp_f32 v41, v41
    v_exp_f32 v42, v42
    v_exp_f32 v43, v43
    v_mfma_f32_32x32x16_bf16 v[56:71], v[108:111], v[92:95], v[56:71]
    v_cvt_pk_bf16_f32 v88, v40, v41
    v_cvt_pk_bf16_f32 v89, v42, v43
    s_add_u32 m0, s76, 0
    s_nop 0
    buffer_load_dwordx4 v114, s[24:27], s51 offen offset:2048 sc1 lds
    v_exp_f32 v44, v44
    v_exp_f32 v45, v45
    v_exp_f32 v46, v46
    v_mfma_f32_32x32x16_bf16 v[24:39], v[100:103], v[12:15], v[24:39]
    v_exp_f32 v47, v47
    v_cvt_pk_bf16_f32 v90, v44, v45
    v_cvt_pk_bf16_f32 v91, v46, v47
    ds_read_b64_tr_b16 a[40:41], v117 offset:128
    ds_read_b64_tr_b16 a[42:43], v117 offset:640
    ds_read_b64_tr_b16 a[44:45], v117 offset:192
    ds_read_b64_tr_b16 a[46:47], v117 offset:704
    v_exp_f32 v48, v48
    v_exp_f32 v49, v49
    v_exp_f32 v50, v50
    v_mfma_f32_32x32x16_bf16 v[72:87], v[104:107], v[88:91], v[72:87]
    ds_read_b128 v[104:107], v112 offset:2048
    v_exp_f32 v51, v51
    v_cvt_pk_bf16_f32 v92, v48, v49
    v_cvt_pk_bf16_f32 v93, v50, v51
    s_add_u32 m0, s76, 0
    s_nop 0
    buffer_load_dwordx4 v114, s[24:27], s51 offen offset:3072 sc1 lds
    v_exp_f32 v52, v52
    v_exp_f32 v53, v53
    v_exp_f32 v54, v54
    v_exp_f32 v55, v55
    v_cvt_pk_bf16_f32 v94, v52, v53
    v_cvt_pk_bf16_f32 v95, v54, v55
    v_mfma_f32_32x32x16_bf16 v[40:55], v[96:99], v[16:19], 0
    ds_read_b128 v[96:99], v112 offset:8192
    v_exp_f32 v24, v24
    v_exp_f32 v25, v25
    v_exp_f32 v26, v26
    v_exp_f32 v27, v27
    v_mfma_f32_32x32x16_bf16 v[72:87], v[108:111], v[92:95], v[72:87]
    ds_read_b128 v[108:111], v112 offset:3072
    v_cvt_pk_bf16_f32 v88, v24, v25
    v_cvt_pk_bf16_f32 v89, v26, v27
    v_exp_f32 v28, v28
    v_exp_f32 v29, v29
    v_exp_f32 v30, v30
    v_mfma_f32_32x32x16_bf16 v[40:55], v[100:103], v[20:23], v[40:55]
    ds_read_b128 v[100:103], v112 offset:9216
    v_exp_f32 v31, v31
    v_cvt_pk_bf16_f32 v90, v28, v29
    v_cvt_pk_bf16_f32 v91, v30, v31
    v_exp_f32 v32, v32
    v_exp_f32 v33, v33
    v_exp_f32 v34, v34
    s_waitcnt lgkmcnt(3)
    v_mfma_f32_32x32x16_bf16 v[56:71], v[104:107], v[88:91], v[56:71]
    v_exp_f32 v35, v35
    v_cvt_pk_bf16_f32 v92, v32, v33
    v_cvt_pk_bf16_f32 v93, v34, v35
    s_mov_b32 m0, s45
    s_add_u32 s59, s46, 39424
    buffer_load_dwordx4 v116, s[16:19], s59 offen offset:0 lds
    v_exp_f32 v36, v36
    v_exp_f32 v37, v37
    v_exp_f32 v38, v38
    v_exp_f32 v39, v39
    v_cvt_pk_bf16_f32 v94, v36, v37
    v_cvt_pk_bf16_f32 v95, v38, v39
    s_waitcnt lgkmcnt(0)
    v_mfma_f32_32x32x16_bf16 v[24:39], v[96:99], v[8:11], 0
    v_exp_f32 v40, v40
    v_exp_f32 v41, v41
    v_exp_f32 v42, v42
    v_exp_f32 v43, v43
    v_mfma_f32_32x32x16_bf16 v[56:71], v[108:111], v[92:95], v[56:71]
    v_cvt_pk_bf16_f32 v88, v40, v41
    v_cvt_pk_bf16_f32 v89, v42, v43
    v_exp_f32 v44, v44
    v_exp_f32 v45, v45
    v_exp_f32 v46, v46
    v_mfma_f32_32x32x16_bf16 v[24:39], v[100:103], v[12:15], v[24:39]
    v_exp_f32 v47, v47
    v_cvt_pk_bf16_f32 v90, v44, v45
    v_cvt_pk_bf16_f32 v91, v46, v47
    s_mov_b32 m0, s45
    s_add_u32 s59, s46, 39232
    buffer_load_dwordx4 v116, s[16:19], s59 offen offset:1088 lds
    v_exp_f32 v48, v48
    v_exp_f32 v49, v49
    v_exp_f32 v50, v50
    v_mfma_f32_32x32x16_bf16 v[72:87], v[104:107], v[88:91], v[72:87]
    ds_read_b128 v[104:107], v112 offset:10240
    v_exp_f32 v51, v51
    v_cvt_pk_bf16_f32 v92, v48, v49
    v_cvt_pk_bf16_f32 v93, v50, v51
    s_mov_b32 m0, s45
    s_add_u32 s59, s46, 39040
    buffer_load_dwordx4 v116, s[16:19], s59 offen offset:2176 lds
    v_exp_f32 v52, v52
    v_exp_f32 v53, v53
    v_exp_f32 v54, v54
    v_exp_f32 v55, v55
    v_cvt_pk_bf16_f32 v94, v52, v53
    v_cvt_pk_bf16_f32 v95, v54, v55
    s_setprio 0
    v_mfma_f32_32x32x16_bf16 v[40:55], v[96:99], v[16:19], 0
    ds_read_b128 v[96:99], v112 offset:16384
    v_exp_f32 v24, v24
    v_exp_f32 v25, v25
    v_exp_f32 v26, v26
    v_exp_f32 v27, v27
    v_mfma_f32_32x32x16_bf16 v[72:87], v[108:111], v[92:95], v[72:87]
    ds_read_b128 v[108:111], v112 offset:11264
    v_cvt_pk_bf16_f32 v88, v24, v25
    v_cvt_pk_bf16_f32 v89, v26, v27
    v_exp_f32 v28, v28
    v_exp_f32 v29, v29
    v_exp_f32 v30, v30
    v_mfma_f32_32x32x16_bf16 v[40:55], v[100:103], v[20:23], v[40:55]
    ds_read_b128 v[100:103], v112 offset:17408
    v_exp_f32 v31, v31
    v_cvt_pk_bf16_f32 v90, v28, v29
    v_cvt_pk_bf16_f32 v91, v30, v31
    s_mov_b32 m0, s45
    s_add_u32 s59, s46, 38848
    buffer_load_dwordx4 v116, s[16:19], s59 offen offset:3264 lds
    v_exp_f32 v32, v32
    v_exp_f32 v33, v33
    v_exp_f32 v34, v34
    s_waitcnt lgkmcnt(3)
    v_mfma_f32_32x32x16_bf16 v[56:71], v[104:107], v[88:91], v[56:71]
    v_exp_f32 v35, v35
    v_cvt_pk_bf16_f32 v92, v32, v33
    v_cvt_pk_bf16_f32 v93, v34, v35
    v_exp_f32 v36, v36
    v_exp_f32 v37, v37
    v_exp_f32 v38, v38
    v_exp_f32 v39, v39
    v_cvt_pk_bf16_f32 v94, v36, v37
    v_cvt_pk_bf16_f32 v95, v38, v39
    s_waitcnt lgkmcnt(0)
    v_mfma_f32_32x32x16_bf16 v[24:39], v[96:99], v[8:11], 0
    v_exp_f32 v40, v40
    v_exp_f32 v41, v41
    v_exp_f32 v42, v42
    v_exp_f32 v43, v43
    v_mfma_f32_32x32x16_bf16 v[56:71], v[108:111], v[92:95], v[56:71]
    v_cvt_pk_bf16_f32 v88, v40, v41
    v_cvt_pk_bf16_f32 v89, v42, v43
    v_exp_f32 v44, v44
    v_exp_f32 v45, v45
    v_exp_f32 v46, v46
    v_mfma_f32_32x32x16_bf16 v[24:39], v[100:103], v[12:15], v[24:39]
    v_exp_f32 v47, v47
    v_cvt_pk_bf16_f32 v90, v44, v45
    v_cvt_pk_bf16_f32 v91, v46, v47
    v_exp_f32 v48, v48
    v_exp_f32 v49, v49
    v_exp_f32 v50, v50
    v_mfma_f32_32x32x16_bf16 v[72:87], v[104:107], v[88:91], v[72:87]
    ds_read_b128 v[104:107], v112 offset:18432
    v_exp_f32 v51, v51
    v_cvt_pk_bf16_f32 v92, v48, v49
    v_cvt_pk_bf16_f32 v93, v50, v51
    v_exp_f32 v52, v52
    v_exp_f32 v53, v53
    v_exp_f32 v54, v54
    v_exp_f32 v55, v55
    v_cvt_pk_bf16_f32 v94, v52, v53
    v_cvt_pk_bf16_f32 v95, v54, v55
    v_mfma_f32_32x32x16_bf16 v[40:55], v[96:99], v[16:19], 0
    ds_read_b128 v[96:99], v112 offset:24576
    v_exp_f32 v24, v24
    v_exp_f32 v25, v25
    v_exp_f32 v26, v26
    v_exp_f32 v27, v27
    v_mfma_f32_32x32x16_bf16 v[72:87], v[108:111], v[92:95], v[72:87]
    ds_read_b128 v[108:111], v112 offset:19456
    v_cvt_pk_bf16_f32 v88, v24, v25
    v_cvt_pk_bf16_f32 v89, v26, v27
    v_exp_f32 v28, v28
    v_exp_f32 v29, v29
    v_exp_f32 v30, v30
    v_mfma_f32_32x32x16_bf16 v[40:55], v[100:103], v[20:23], v[40:55]
    ds_read_b128 v[100:103], v112 offset:25600
    v_exp_f32 v31, v31
    v_cvt_pk_bf16_f32 v90, v28, v29
    v_cvt_pk_bf16_f32 v91, v30, v31
    v_exp_f32 v32, v32
    v_exp_f32 v33, v33
    v_exp_f32 v34, v34
    s_waitcnt lgkmcnt(3)
    v_mfma_f32_32x32x16_bf16 v[56:71], v[104:107], v[88:91], v[56:71]
    v_exp_f32 v35, v35
    v_cvt_pk_bf16_f32 v92, v32, v33
    v_cvt_pk_bf16_f32 v93, v34, v35
    v_exp_f32 v36, v36
    v_exp_f32 v37, v37
    v_exp_f32 v38, v38
    v_exp_f32 v39, v39
    v_cvt_pk_bf16_f32 v94, v36, v37
    v_cvt_pk_bf16_f32 v95, v38, v39
    s_waitcnt lgkmcnt(0)
    v_mfma_f32_32x32x16_bf16 v[24:39], v[96:99], v[8:11], 0
    v_exp_f32 v40, v40
    v_exp_f32 v41, v41
    v_exp_f32 v42, v42
    v_exp_f32 v43, v43
    v_mfma_f32_32x32x16_bf16 v[56:71], v[108:111], v[92:95], v[56:71]
    v_cvt_pk_bf16_f32 v88, v40, v41
    v_cvt_pk_bf16_f32 v89, v42, v43
    v_exp_f32 v44, v44
    v_exp_f32 v45, v45
    v_exp_f32 v46, v46
    v_mfma_f32_32x32x16_bf16 v[24:39], v[100:103], v[12:15], v[24:39]
    v_exp_f32 v47, v47
    v_cvt_pk_bf16_f32 v90, v44, v45
    v_cvt_pk_bf16_f32 v91, v46, v47
    v_exp_f32 v48, v48
    v_exp_f32 v49, v49
    v_exp_f32 v50, v50
    v_mfma_f32_32x32x16_bf16 v[72:87], v[104:107], v[88:91], v[72:87]
    ds_read_b128 v[104:107], v112 offset:26624
    v_exp_f32 v51, v51
    v_cvt_pk_bf16_f32 v92, v48, v49
    v_cvt_pk_bf16_f32 v93, v50, v51
    v_exp_f32 v52, v52
    v_exp_f32 v53, v53
    v_exp_f32 v54, v54
    v_exp_f32 v55, v55
    v_cvt_pk_bf16_f32 v94, v52, v53
    v_cvt_pk_bf16_f32 v95, v54, v55
    s_waitcnt vmcnt(0) lgkmcnt(0)
    s_barrier
    ds_read_b64_tr_b16 a[48:49], v117 offset:0
    ds_read_b64_tr_b16 a[50:51], v117 offset:512
    ds_read_b64_tr_b16 a[52:53], v117 offset:64
    ds_read_b64_tr_b16 a[54:55], v117 offset:576
    s_setprio 1
    v_mfma_f32_32x32x16_bf16 v[40:55], v[96:99], v[16:19], 0
    ds_read_b128 v[96:99], v120 offset:0
    v_exp_f32 v24, v24
    v_exp_f32 v25, v25
    v_exp_f32 v26, v26
    v_exp_f32 v27, v27
    v_mfma_f32_32x32x16_bf16 v[72:87], v[108:111], v[92:95], v[72:87]
    ds_read_b128 v[108:111], v112 offset:27648
    v_cvt_pk_bf16_f32 v88, v24, v25
    v_cvt_pk_bf16_f32 v89, v26, v27
    s_bitcmp1_b32 s70, 5
    s_cbranch_scc0 L_SLOW3
L_FAST3:
    s_add_u32 s51, s57, 5
    s_and_b32 s51, s51, 7
    s_lshl_b32 s51, s51, 15
    s_add_u32 m0, s76, 32768
    s_nop 0
    buffer_load_dwordx4 v114, s[24:27], s51 offen offset:0 sc1 lds
    v_exp_f32 v28, v28
    v_exp_f32 v29, v29
    v_exp_f32 v30, v30
    v_mfma_f32_32x32x16_bf16 v[40:55], v[100:103], v[20:23], v[40:55]
    ds_read_b128 v[100:103], v120 offset:1024
    v_exp_f32 v31, v31
    v_cvt_pk_bf16_f32 v90, v28, v29
    v_cvt_pk_bf16_f32 v91, v30, v31
    v_exp_f32 v32, v32
    v_exp_f32 v33, v33
    v_exp_f32 v34, v34
    s_waitcnt lgkmcnt(3)
    v_mfma_f32_32x32x16_bf16 v[56:71], v[104:107], v[88:91], v[56:71]
    v_exp_f32 v35, v35
    v_cvt_pk_bf16_f32 v92, v32, v33
    v_cvt_pk_bf16_f32 v93, v34, v35
    s_add_u32 m0, s76, 32768
    s_nop 0
    buffer_load_dwordx4 v114, s[24:27], s51 offen offset:1024 sc1 lds
    v_exp_f32 v36, v36
    v_exp_f32 v37, v37
    v_exp_f32 v38, v38
    v_exp_f32 v39, v39
    v_cvt_pk_bf16_f32 v94, v36, v37
    v_cvt_pk_bf16_f32 v95, v38, v39
    s_waitcnt lgkmcnt(0)
    v_mfma_f32_32x32x16_bf16 v[24:39], v[96:99], v[8:11], 0
    v_exp_f32 v40, v40
    v_exp_f32 v41, v41
    v_exp_f32 v42, v42
    v_exp_f32 v43, v43
    v_mfma_f32_32x32x16_bf16 v[56:71], v[108:111], v[92:95], v[56:71]
    v_cvt_pk_bf16_f32 v88, v40, v41
    v_cvt_pk_bf16_f32 v89, v42, v43
    s_add_u32 m0, s76, 32768
    s_nop 0
    buffer_load_dwordx4 v114, s[24:27], s51 offen offset:2048 sc1 lds
    v_exp_f32 v44, v44
    v_exp_f32 v45, v45
    v_exp_f32 v46, v46
    v_mfma_f32_32x32x16_bf16 v[24:39], v[100:103], v[12:15], v[24:39]
    v_exp_f32 v47, v47
    v_cvt_pk_bf16_f32 v90, v44, v45
    v_cvt_pk_bf16_f32 v91, v46, v47
    ds_read_b64_tr_b16 a[56:57], v117 offset:128
    ds_read_b64_tr_b16 a[58:59], v117 offset:640
    ds_read_b64_tr_b16 a[60:61], v117 offset:192
    ds_read_b64_tr_b16 a[62:63], v117 offset:704
    v_exp_f32 v48, v48
    v_exp_f32 v49, v49
    v_exp_f32 v50, v50
    v_mfma_f32_32x32x16_bf16 v[72:87], v[104:107], v[88:91], v[72:87]
    ds_read_b128 v[104:107], v120 offset:2048
    v_exp_f32 v51, v51
    v_cvt_pk_bf16_f32 v92, v48, v49
    v_cvt_pk_bf16_f32 v93, v50, v51
    s_add_u32 m0, s76, 32768
    s_nop 0
    buffer_load_dwordx4 v114, s[24:27], s51 offen offset:3072 sc1 lds
    v_exp_f32 v52, v52
    v_exp_f32 v53, v53
    v_exp_f32 v54, v54
    v_exp_f32 v55, v55
    v_cvt_pk_bf16_f32 v94, v52, v53
    v_cvt_pk_bf16_f32 v95, v54, v55
    v_mfma_f32_32x32x16_bf16 v[40:55], v[96:99], v[16:19], 0
    ds_read_b128 v[96:99], v120 offset:8192
    v_exp_f32 v24, v24
    v_exp_f32 v25, v25
    v_exp_f32 v26, v26
    v_exp_f32 v27, v27
    v_mfma_f32_32x32x16_bf16 v[72:87], v[108:111], v[92:95], v[72:87]
    ds_read_b128 v[108:111], v120 offset:3072
    v_cvt_pk_bf16_f32 v88, v24, v25
    v_cvt_pk_bf16_f32 v89, v26, v27
    v_exp_f32 v28, v28
    v_exp_f32 v29, v29
    v_exp_f32 v30, v30
    v_mfma_f32_32x32x16_bf16 v[40:55], v[100:103], v[20:23], v[40:55]
    ds_read_b128 v[100:103], v120 offset:9216
    v_exp_f32 v31, v31
    v_cvt_pk_bf16_f32 v90, v28, v29
    v_cvt_pk_bf16_f32 v91, v30, v31
    v_exp_f32 v32, v32
    v_exp_f32 v33, v33
    v_exp_f32 v34, v34
    s_waitcnt lgkmcnt(3)
    v_mfma_f32_32x32x16_bf16 v[56:71], v[104:107], v[88:91], v[56:71]
    v_exp_f32 v35, v35
    v_cvt_pk_bf16_f32 v92, v32, v33
    v_cvt_pk_bf16_f32 v93, v34, v35
    s_mov_b32 m0, s45
    s_add_u32 s59, s46, 50176
    buffer_load_dwordx4 v116, s[16:19], s59 offen offset:0 lds
    v_exp_f32 v36, v36
    v_exp_f32 v37, v37
    v_exp_f32 v38, v38
    v_exp_f32 v39, v39
    v_cvt_pk_bf16_f32 v94, v36, v37
    v_cvt_pk_bf16_f32 v95, v38, v39
    s_waitcnt lgkmcnt(0)
    v_mfma_f32_32x32x16_bf16 v[24:39], v[96:99], v[8:11], 0
    v_exp_f32 v40, v40
    v_exp_f32 v41, v41
    v_exp_f32 v42, v42
    v_exp_f32 v43, v43
    v_mfma_f32_32x32x16_bf16 v[56:71], v[108:111], v[92:95], v[56:71]
    v_cvt_pk_bf16_f32 v88, v40, v41
    v_cvt_pk_bf16_f32 v89, v42, v43
    v_exp_f32 v44, v44
    v_exp_f32 v45, v45
    v_exp_f32 v46, v46
    v_mfma_f32_32x32x16_bf16 v[24:39], v[100:103], v[12:15], v[24:39]
    v_exp_f32 v47, v47
    v_cvt_pk_bf16_f32 v90, v44, v45
    v_cvt_pk_bf16_f32 v91, v46, v47
    s_mov_b32 m0, s45
    s_add_u32 s59, s46, 49984
    buffer_load_dwordx4 v116, s[16:19], s59 offen offset:1088 lds
    v_exp_f32 v48, v48
    v_exp_f32 v49, v49
    v_exp_f32 v50, v50
    v_mfma_f32_32x32x16_bf16 v[72:87], v[104:107], v[88:91], v[72:87]
    ds_read_b128 v[104:107], v120 offset:10240
    v_exp_f32 v51, v51
    v_cvt_pk_bf16_f32 v92, v48, v49
    v_cvt_pk_bf16_f32 v93, v50, v51
    s_mov_b32 m0, s45
    s_add_u32 s59, s46, 49792
    buffer_load_dwordx4 v116, s[16:19], s59 offen offset:2176 lds
    v_exp_f32 v52, v52
    v_exp_f32 v53, v53
    v_exp_f32 v54, v54
    v_exp_f32 v55, v55
    v_cvt_pk_bf16_f32 v94, v52, v53
    v_cvt_pk_bf16_f32 v95, v54, v55
    s_setprio 0
    v_mfma_f32_32x32x16_bf16 v[40:55], v[96:99], v[16:19], 0
    ds_read_b128 v[96:99], v120 offset:16384
    v_exp_f32 v24, v24
    v_exp_f32 v25, v25
    v_exp_f32 v26, v26
    v_exp_f32 v27, v27
    v_mfma_f32_32x32x16_bf16 v[72:87], v[108:111], v[92:95], v[72:87]
    ds_read_b128 v[108:111], v120 offset:11264
    v_cvt_pk_bf16_f32 v88, v24, v25
    v_cvt_pk_bf16_f32 v89, v26, v27
    v_exp_f32 v28, v28
    v_exp_f32 v29, v29
    v_exp_f32 v30, v30
    v_mfma_f32_32x32x16_bf16 v[40:55], v[100:103], v[20:23], v[40:55]
    ds_read_b128 v[100:103], v120 offset:17408
    v_exp_f32 v31, v31
    v_cvt_pk_bf16_f32 v90, v28, v29
    v_cvt_pk_bf16_f32 v91, v30, v31
    s_mov_b32 m0, s45
    s_add_u32 s59, s46, 49600
    buffer_load_dwordx4 v116, s[16:19], s59 offen offset:3264 lds
    v_exp_f32 v32, v32
    v_exp_f32 v33, v33
    v_exp_f32 v34, v34
    s_waitcnt lgkmcnt(3)
    v_mfma_f32_32x32x16_bf16 v[56:71], v[104:107], v[88:91], v[56:71]
    v_exp_f32 v35, v35
    v_cvt_pk_bf16_f32 v92, v32, v33
    v_cvt_pk_bf16_f32 v93, v34, v35
    v_exp_f32 v36, v36
    v_exp_f32 v37, v37
    v_exp_f32 v38, v38
    v_exp_f32 v39, v39
    v_cvt_pk_bf16_f32 v94, v36, v37
    v_cvt_pk_bf16_f32 v95, v38, v39
    s_waitcnt lgkmcnt(0)
    v_mfma_f32_32x32x16_bf16 v[24:39], v[96:99], v[8:11], 0
    v_exp_f32 v40, v40
    v_exp_f32 v41, v41
    v_exp_f32 v42, v42
    v_exp_f32 v43, v43
    v_mfma_f32_32x32x16_bf16 v[56:71], v[108:111], v[92:95], v[56:71]
    v_cvt_pk_bf16_f32 v88, v40, v41
    v_cvt_pk_bf16_f32 v89, v42, v43
    v_exp_f32 v44, v44
    v_exp_f32 v45, v45
    v_exp_f32 v46, v46
    v_mfma_f32_32x32x16_bf16 v[24:39], v[100:103], v[12:15], v[24:39]
    v_exp_f32 v47, v47
    v_cvt_pk_bf16_f32 v90, v44, v45
    v_cvt_pk_bf16_f32 v91, v46, v47
    v_exp_f32 v48, v48
    v_exp_f32 v49, v49
    v_exp_f32 v50, v50
    v_mfma_f32_32x32x16_bf16 v[72:87], v[104:107], v[88:91], v[72:87]
    ds_read_b128 v[104:107], v120 offset:18432
    v_exp_f32 v51, v51
    v_cvt_pk_bf16_f32 v92, v48, v49
    v_cvt_pk_bf16_f32 v93, v50, v51
    v_exp_f32 v52, v52
    v_exp_f32 v53, v53
    v_exp_f32 v54, v54
    v_exp_f32 v55, v55
    v_cvt_pk_bf16_f32 v94, v52, v53
    v_cvt_pk_bf16_f32 v95, v54, v55
    v_mfma_f32_32x32x16_bf16 v[40:55], v[96:99], v[16:19], 0
    ds_read_b128 v[96:99], v120 offset:24576
    v_exp_f32 v24, v24
    v_exp_f32 v25, v25
    v_exp_f32 v26, v26
    v_exp_f32 v27, v27
    v_mfma_f32_32x32x16_bf16 v[72:87], v[108:111], v[92:95], v[72:87]
    ds_read_b128 v[108:111], v120 offset:19456
    v_cvt_pk_bf16_f32 v88, v24, v25
    v_cvt_pk_bf16_f32 v89, v26, v27
    v_exp_f32 v28, v28
    v_exp_f32 v29, v29
    v_exp_f32 v30, v30
    v_mfma_f32_32x32x16_bf16 v[40:55], v[100:103], v[20:23], v[40:55]
    ds_read_b128 v[100:103], v120 offset:25600
    v_exp_f32 v31, v31
    v_cvt_pk_bf16_f32 v90, v28, v29
    v_cvt_pk_bf16_f32 v91, v30, v31
    v_exp_f32 v32, v32
    v_exp_f32 v33, v33
    v_exp_f32 v34, v34
    s_waitcnt lgkmcnt(3)
    v_mfma_f32_32x32x16_bf16 v[56:71], v[104:107], v[88:91], v[56:71]
    v_exp_f32 v35, v35
    v_cvt_pk_bf16_f32 v92, v32, v33
    v_cvt_pk_bf16_f32 v93, v34, v35
    v_exp_f32 v36, v36
    v_exp_f32 v37, v37
    v_exp_f32 v38, v38
    v_exp_f32 v39, v39
    v_cvt_pk_bf16_f32 v94, v36, v37
    v_cvt_pk_bf16_f32 v95, v38, v39
    s_waitcnt lgkmcnt(0)
    v_mfma_f32_32x32x16_bf16 v[24:39], v[96:99], v[8:11], 0
    v_exp_f32 v40, v40
    v_exp_f32 v41, v41
    v_exp_f32 v42, v42
    v_exp_f32 v43, v43
    v_mfma_f32_32x32x16_bf16 v[56:71], v[108:111], v[92:95], v[56:71]
    v_cvt_pk_bf16_f32 v88, v40, v41
    v_cvt_pk_bf16_f32 v89, v42, v43
    v_exp_f32 v44, v44
    v_exp_f32 v45, v45
    v_exp_f32 v46, v46
    v_mfma_f32_32x32x16_bf16 v[24:39], v[100:103], v[12:15], v[24:39]
    v_exp_f32 v47, v47
    v_cvt_pk_bf16_f32 v90, v44, v45
    v_cvt_pk_bf16_f32 v91, v46, v47
    v_exp_f32 v48, v48
    v_exp_f32 v49, v49
    v_exp_f32 v50, v50
    v_mfma_f32_32x32x16_bf16 v[72:87], v[104:107], v[88:91], v[72:87]
    ds_read_b128 v[104:107], v120 offset:26624
    v_exp_f32 v51, v51
    v_cvt_pk_bf16_f32 v92, v48, v49
    v_cvt_pk_bf16_f32 v93, v50, v51
    v_exp_f32 v52, v52
    v_exp_f32 v53, v53
    v_exp_f32 v54, v54
    v_exp_f32 v55, v55
    v_cvt_pk_bf16_f32 v94, v52, v53
    v_cvt_pk_bf16_f32 v95, v54, v55
    s_waitcnt vmcnt(0) lgkmcnt(0)
    s_barrier
    ds_read_b64_tr_b16 a[64:65], v117 offset:0
    ds_read_b64_tr_b16 a[66:67], v117 offset:512
    ds_read_b64_tr_b16 a[68:69], v117 offset:64
    ds_read_b64_tr_b16 a[70:71], v117 offset:576
    s_setprio 1
    v_mfma_f32_32x32x16_bf16 v[40:55], v[96:99], v[16:19], 0
    ds_read_b128 v[96:99], v120 offset:32768
    v_exp_f32 v24, v24
    v_exp_f32 v25, v25
    v_exp_f32 v26, v26
    v_exp_f32 v27, v27
    v_mfma_f32_32x32x16_bf16 v[72:87], v[108:111], v[92:95], v[72:87]
    ds_read_b128 v[108:111], v120 offset:27648
    v_cvt_pk_bf16_f32 v88, v24, v25
    v_cvt_pk_bf16_f32 v89, v26, v27
    s_bitcmp1_b32 s70, 6
    s_cbranch_scc0 L_SLOW4
L_FAST4:
    s_add_u32 s51, s57, 6
    s_and_b32 s51, s51, 7
    s_lshl_b32 s51, s51, 15
    s_add_u32 m0, s76, 126976
    s_nop 0
    buffer_load_dwordx4 v114, s[24:27], s51 offen offset:0 sc1 lds
    v_exp_f32 v28, v28
    v_exp_f32 v29, v29
    v_exp_f32 v30, v30
    v_mfma_f32_32x32x16_bf16 v[40:55], v[100:103], v[20:23], v[40:55]
    ds_read_b128 v[100:103], v120 offset:33792
    v_exp_f32 v31, v31
    v_cvt_pk_bf16_f32 v90, v28, v29
    v_cvt_pk_bf16_f32 v91, v30, v31
    v_exp_f32 v32, v32
    v_exp_f32 v33, v33
    v_exp_f32 v34, v34
    s_waitcnt lgkmcnt(3)
    v_mfma_f32_32x32x16_bf16 v[56:71], v[104:107], v[88:91], v[56:71]
    v_exp_f32 v35, v35
    v_cvt_pk_bf16_f32 v92, v32, v33
    v_cvt_pk_bf16_f32 v93, v34, v35
    s_add_u32 m0, s76, 126976
    s_nop 0
    buffer_load_dwordx4 v114, s[24:27], s51 offen offset:1024 sc1 lds
    v_exp_f32 v36, v36
    v_exp_f32 v37, v37
    v_exp_f32 v38, v38
    v_exp_f32 v39, v39
    v_cvt_pk_bf16_f32 v94, v36, v37
    v_cvt_pk_bf16_f32 v95, v38, v39
    s_waitcnt lgkmcnt(0)
    v_mfma_f32_32x32x16_bf16 v[24:39], v[96:99], v[8:11], 0
    v_exp_f32 v40, v40
    v_exp_f32 v41, v41
    v_exp_f32 v42, v42
    v_exp_f32 v43, v43
    v_mfma_f32_32x32x16_bf16 v[56:71], v[108:111], v[92:95], v[56:71]
    v_cvt_pk_bf16_f32 v88, v40, v41
    v_cvt_pk_bf16_f32 v89, v42, v43
    s_add_u32 m0, s76, 126976
    s_nop 0
    buffer_load_dwordx4 v114, s[24:27], s51 offen offset:2048 sc1 lds
    v_exp_f32 v44, v44
    v_exp_f32 v45, v45
    v_exp_f32 v46, v46
    v_mfma_f32_32x32x16_bf16 v[24:39], v[100:103], v[12:15], v[24:39]
    v_exp_f32 v47, v47
    v_cvt_pk_bf16_f32 v90, v44, v45
    v_cvt_pk_bf16_f32 v91, v46, v47
    ds_read_b64_tr_b16 a[72:73], v117 offset:128
    ds_read_b64_tr_b16 a[74:75], v117 offset:640
    ds_read_b64_tr_b16 a[76:77], v117 offset:192
    ds_read_b64_tr_b16 a[78:79], v117 offset:704
    v_exp_f32 v48, v48
    v_exp_f32 v49, v49
    v_exp_f32 v50, v50
    v_mfma_f32_32x32x16_bf16 v[72:87], v[104:107], v[88:91], v[72:87]
    ds_read_b128 v[104:107], v120 offset:34816
    v_exp_f32 v51, v51
    v_cvt_pk_bf16_f32 v92, v48, v49
    v_cvt_pk_bf16_f32 v93, v50, v51
    s_add_u32 m0, s76, 126976
    s_nop 0
    buffer_load_dwordx4 v114, s[24:27], s51 offen offset:3072 sc1 lds
    v_exp_f32 v52, v52
    v_exp_f32 v53, v53
    v_exp_f32 v54, v54
    v_exp_f32 v55, v55
    v_cvt_pk_bf16_f32 v94, v52, v53
    v_cvt_pk_bf16_f32 v95, v54, v55
    v_mfma_f32_32x32x16_bf16 v[40:55], v[96:99], v[16:19], 0
    ds_read_b128 v[96:99], v120 offset:40960
    v_exp_f32 v24, v24
    v_exp_f32 v25, v25
    v_exp_f32 v26, v26
    v_exp_f32 v27, v27
    v_mfma_f32_32x32x16_bf16 v[72:87], v[108:111], v[92:95], v[72:87]
    ds_read_b128 v[108:111], v120 offset:35840
    v_cvt_pk_bf16_f32 v88, v24, v25
    v_cvt_pk_bf16_f32 v89, v26, v27
    v_exp_f32 v28, v28
    v_exp_f32 v29, v29
    v_exp_f32 v30, v30
    v_mfma_f32_32x32x16_bf16 v[40:55], v[100:103], v[20:23], v[40:55]
    ds_read_b128 v[100:103], v120 offset:41984
    v_exp_f32 v31, v31
    v_cvt_pk_bf16_f32 v90, v28, v29
    v_cvt_pk_bf16_f32 v91, v30, v31
    v_exp_f32 v32, v32
    v_exp_f32 v33, v33
    v_exp_f32 v34, v34
    s_waitcnt lgkmcnt(3)
    v_mfma_f32_32x32x16_bf16 v[56:71], v[104:107], v[88:91], v[56:71]
    v_exp_f32 v35, v35
    v_cvt_pk_bf16_f32 v92, v32, v33
    v_cvt_pk_bf16_f32 v93, v34, v35
    s_mov_b32 m0, s45
    s_add_u32 s59, s46, 64512
    buffer_load_dwordx4 v116, s[16:19], s59 offen offset:0 lds
    v_exp_f32 v36, v36
    v_exp_f32 v37, v37
    v_exp_f32 v38, v38
    v_exp_f32 v39, v39
    v_cvt_pk_bf16_f32 v94, v36, v37
    v_cvt_pk_bf16_f32 v95, v38, v39
    s_waitcnt lgkmcnt(0)
    v_mfma_f32_32x32x16_bf16 v[24:39], v[96:99], v[8:11], 0
    v_exp_f32 v40, v40
    v_exp_f32 v41, v41
    v_exp_f32 v42, v42
    v_exp_f32 v43, v43
    v_mfma_f32_32x32x16_bf16 v[56:71], v[108:111], v[92:95], v[56:71]
    v_cvt_pk_bf16_f32 v88, v40, v41
    v_cvt_pk_bf16_f32 v89, v42, v43
    v_exp_f32 v44, v44
    v_exp_f32 v45, v45
    v_exp_f32 v46, v46
    v_mfma_f32_32x32x16_bf16 v[24:39], v[100:103], v[12:15], v[24:39]
    v_exp_f32 v47, v47
    v_cvt_pk_bf16_f32 v90, v44, v45
    v_cvt_pk_bf16_f32 v91, v46, v47
    s_mov_b32 m0, s45
    s_add_u32 s59, s46, 64320
    buffer_load_dwordx4 v116, s[16:19], s59 offen offset:1088 lds
    v_exp_f32 v48, v48
    v_exp_f32 v49, v49
    v_exp_f32 v50, v50
    v_mfma_f32_32x32x16_bf16 v[72:87], v[104:107], v[88:91], v[72:87]
    ds_read_b128 v[104:107], v120 offset:43008
    v_exp_f32 v51, v51
    v_cvt_pk_bf16_f32 v92, v48, v49
    v_cvt_pk_bf16_f32 v93, v50, v51
    s_mov_b32 m0, s45
    s_add_u32 s59, s46, 64128
    buffer_load_dwordx4 v116, s[16:19], s59 offen offset:2176 lds
    v_exp_f32 v52, v52
    v_exp_f32 v53, v53
    v_exp_f32 v54, v54
    v_exp_f32 v55, v55
    v_cvt_pk_bf16_f32 v94, v52, v53
    v_cvt_pk_bf16_f32 v95, v54, v55
    s_setprio 0
    v_mfma_f32_32x32x16_bf16 v[40:55], v[96:99], v[16:19], 0
    ds_read_b128 v[96:99], v120 offset:49152
    v_exp_f32 v24, v24
    v_exp_f32 v25, v25
    v_exp_f32 v26, v26
    v_exp_f32 v27, v27
    v_mfma_f32_32x32x16_bf16 v[72:87], v[108:111], v[92:95], v[72:87]
    ds_read_b128 v[108:111], v120 offset:44032
    v_cvt_pk_bf16_f32 v88, v24, v25
    v_cvt_pk_bf16_f32 v89, v26, v27
    v_exp_f32 v28, v28
    v_exp_f32 v29, v29
    v_exp_f32 v30, v30
    v_mfma_f32_32x32x16_bf16 v[40:55], v[100:103], v[20:23], v[40:55]
    ds_read_b128 v[100:103], v120 offset:50176
    v_exp_f32 v31, v31
    v_cvt_pk_bf16_f32 v90, v28, v29
    v_cvt_pk_bf16_f32 v91, v30, v31
    s_mov_b32 m0, s45
    s_add_u32 s59, s46, 63936
    buffer_load_dwordx4 v116, s[16:19], s59 offen offset:3264 lds
    v_exp_f32 v32, v32
    v_exp_f32 v33, v33
    v_exp_f32 v34, v34
    s_waitcnt lgkmcnt(3)
    v_mfma_f32_32x32x16_bf16 v[56:71], v[104:107], v[88:91], v[56:71]
    v_exp_f32 v35, v35
    v_cvt_pk_bf16_f32 v92, v32, v33
    v_cvt_pk_bf16_f32 v93, v34, v35
    v_exp_f32 v36, v36
    v_exp_f32 v37, v37
    v_exp_f32 v38, v38
    v_exp_f32 v39, v39
    v_cvt_pk_bf16_f32 v94, v36, v37
    v_cvt_pk_bf16_f32 v95, v38, v39
    s_waitcnt lgkmcnt(0)
    v_mfma_f32_32x32x16_bf16 v[24:39], v[96:99], v[8:11], 0
    v_exp_f32 v40, v40
    v_exp_f32 v41, v41
    v_exp_f32 v42, v42
    v_exp_f32 v43, v43
    v_mfma_f32_32x32x16_bf16 v[56:71], v[108:111], v[92:95], v[56:71]
    v_cvt_pk_bf16_f32 v88, v40, v41
    v_cvt_pk_bf16_f32 v89, v42, v43
    v_exp_f32 v44, v44
    v_exp_f32 v45, v45
    v_exp_f32 v46, v46
    v_mfma_f32_32x32x16_bf16 v[24:39], v[100:103], v[12:15], v[24:39]
    v_exp_f32 v47, v47
    v_cvt_pk_bf16_f32 v90, v44, v45
    v_cvt_pk_bf16_f32 v91, v46, v47
    v_exp_f32 v48, v48
    v_exp_f32 v49, v49
    v_exp_f32 v50, v50
    v_mfma_f32_32x32x16_bf16 v[72:87], v[104:107], v[88:91], v[72:87]
    ds_read_b128 v[104:107], v120 offset:51200
    v_exp_f32 v51, v51
    v_cvt_pk_bf16_f32 v92, v48, v49
    v_cvt_pk_bf16_f32 v93, v50, v51
    v_exp_f32 v52, v52
    v_exp_f32 v53, v53
    v_exp_f32 v54, v54
    v_exp_f32 v55, v55
    v_cvt_pk_bf16_f32 v94, v52, v53
    v_cvt_pk_bf16_f32 v95, v54, v55
    v_mfma_f32_32x32x16_bf16 v[40:55], v[96:99], v[16:19], 0
    ds_read_b128 v[96:99], v120 offset:57344
    v_exp_f32 v24, v24
    v_exp_f32 v25, v25
    v_exp_f32 v26, v26
    v_exp_f32 v27, v27
    v_mfma_f32_32x32x16_bf16 v[72:87], v[108:111], v[92:95], v[72:87]
    ds_read_b128 v[108:111], v120 offset:52224
    v_cvt_pk_bf16_f32 v88, v24, v25
    v_cvt_pk_bf16_f32 v89, v26, v27
    v_exp_f32 v28, v28
    v_exp_f32 v29, v29
    v_exp_f32 v30, v30
    v_mfma_f32_32x32x16_bf16 v[40:55], v[100:103], v[20:23], v[40:55]
    ds_read_b128 v[100:103], v120 offset:58368
    v_exp_f32 v31, v31
    v_cvt_pk_bf16_f32 v90, v28, v29
    v_cvt_pk_bf16_f32 v91, v30, v31
    v_exp_f32 v32, v32
    v_exp_f32 v33, v33
    v_exp_f32 v34, v34
    s_waitcnt lgkmcnt(3)
    v_mfma_f32_32x32x16_bf16 v[56:71], v[104:107], v[88:91], v[56:71]
    v_exp_f32 v35, v35
    v_cvt_pk_bf16_f32 v92, v32, v33
    v_cvt_pk_bf16_f32 v93, v34, v35
    v_exp_f32 v36, v36
    v_exp_f32 v37, v37
    v_exp_f32 v38, v38
    v_exp_f32 v39, v39
    v_cvt_pk_bf16_f32 v94, v36, v37
    v_cvt_pk_bf16_f32 v95, v38, v39
    s_waitcnt lgkmcnt(0)
    v_mfma_f32_32x32x16_bf16 v[24:39], v[96:99], v[8:11], 0
    v_exp_f32 v40, v40
    v_exp_f32 v41, v41
    v_exp_f32 v42, v42
    v_exp_f32 v43, v43
    v_mfma_f32_32x32x16_bf16 v[56:71], v[108:111], v[92:95], v[56:71]
    v_cvt_pk_bf16_f32 v88, v40, v41
    v_cvt_pk_bf16_f32 v89, v42, v43
    v_exp_f32 v44, v44
    v_exp_f32 v45, v45
    v_exp_f32 v46, v46
    v_mfma_f32_32x32x16_bf16 v[24:39], v[100:103], v[12:15], v[24:39]
    v_exp_f32 v47, v47
    v_cvt_pk_bf16_f32 v90, v44, v45
    v_cvt_pk_bf16_f32 v91, v46, v47
    v_exp_f32 v48, v48
    v_exp_f32 v49, v49
    v_exp_f32 v50, v50
    v_mfma_f32_32x32x16_bf16 v[72:87], v[104:107], v[88:91], v[72:87]
    ds_read_b128 v[104:107], v120 offset:59392
    v_exp_f32 v51, v51
    v_cvt_pk_bf16_f32 v92, v48, v49
    v_cvt_pk_bf16_f32 v93, v50, v51
    v_exp_f32 v52, v52
    v_exp_f32 v53, v53
    v_exp_f32 v54, v54
    v_exp_f32 v55, v55
    v_cvt_pk_bf16_f32 v94, v52, v53
    v_cvt_pk_bf16_f32 v95, v54, v55
    s_waitcnt vmcnt(0) lgkmcnt(0)
    s_barrier
    ds_read_b64_tr_b16 a[80:81], v117 offset:0
    ds_read_b64_tr_b16 a[82:83], v117 offset:512
    ds_read_b64_tr_b16 a[84:85], v117 offset:64
    ds_read_b64_tr_b16 a[86:87], v117 offset:576
    s_setprio 1
    v_mfma_f32_32x32x16_bf16 v[40:55], v[96:99], v[16:19], 0
    ds_read_b128 v[96:99], v112 offset:0
    v_exp_f32 v24, v24
    v_exp_f32 v25, v25
    v_exp_f32 v26, v26
    v_exp_f32 v27, v27
    v_mfma_f32_32x32x16_bf16 v[72:87], v[108:111], v[92:95], v[72:87]
    ds_read_b128 v[108:111], v120 offset:60416
    v_cvt_pk_bf16_f32 v88, v24, v25
    v_cvt_pk_bf16_f32 v89, v26, v27
    s_bitcmp1_b32 s70, 7
    s_cbranch_scc0 L_SLOW5
L_FAST5:
    s_add_u32 s51, s57, 7
    s_and_b32 s51, s51, 7
    s_lshl_b32 s51, s51, 15
    s_add_u32 m0, s76, 0
    s_nop 0
    buffer_load_dwordx4 v114, s[24:27], s51 offen offset:0 sc1 lds
    v_exp_f32 v28, v28
    v_exp_f32 v29, v29
    v_exp_f32 v30, v30
    v_mfma_f32_32x32x16_bf16 v[40:55], v[100:103], v[20:23], v[40:55]
    ds_read_b128 v[100:103], v112 offset:1024
    v_exp_f32 v31, v31
    v_cvt_pk_bf16_f32 v90, v28, v29
    v_cvt_pk_bf16_f32 v91, v30, v31
    v_exp_f32 v32, v32
    v_exp_f32 v33, v33
    v_exp_f32 v34, v34
    s_waitcnt lgkmcnt(3)
    v_mfma_f32_32x32x16_bf16 v[56:71], v[104:107], v[88:91], v[56:71]
    v_exp_f32 v35, v35
    v_cvt_pk_bf16_f32 v92, v32, v33
    v_cvt_pk_bf16_f32 v93, v34, v35
    s_add_u32 m0, s76, 0
    s_nop 0
    buffer_load_dwordx4 v114, s[24:27], s51 offen offset:1024 sc1 lds
    v_exp_f32 v36, v36
    v_exp_f32 v37, v37
    v_exp_f32 v38, v38
    v_exp_f32 v39, v39
    v_cvt_pk_bf16_f32 v94, v36, v37
    v_cvt_pk_bf16_f32 v95, v38, v39
    s_waitcnt lgkmcnt(0)
    v_mfma_f32_32x32x16_bf16 v[24:39], v[96:99], v[8:11], 0
    v_exp_f32 v40, v40
    v_exp_f32 v41, v41
    v_exp_f32 v42, v42
    v_exp_f32 v43, v43
    v_mfma_f32_32x32x16_bf16 v[56:71], v[108:111], v[92:95], v[56:71]
    v_cvt_pk_bf16_f32 v88, v40, v41
    v_cvt_pk_bf16_f32 v89, v42, v43
    s_add_u32 m0, s76, 0
    s_nop 0
    buffer_load_dwordx4 v114, s[24:27], s51 offen offset:2048 sc1 lds
    v_exp_f32 v44, v44
    v_exp_f32 v45, v45
    v_exp_f32 v46, v46
    v_mfma_f32_32x32x16_bf16 v[24:39], v[100:103], v[12:15], v[24:39]
    v_exp_f32 v47, v47
    v_cvt_pk_bf16_f32 v90, v44, v45
    v_cvt_pk_bf16_f32 v91, v46, v47
    ds_read_b64_tr_b16 a[88:89], v117 offset:128
    ds_read_b64_tr_b16 a[90:91], v117 offset:640
    ds_read_b64_tr_b16 a[92:93], v117 offset:192
    ds_read_b64_tr_b16 a[94:95], v117 offset:704
    v_exp_f32 v48, v48
    v_exp_f32 v49, v49
    v_exp_f32 v50, v50
    v_mfma_f32_32x32x16_bf16 v[72:87], v[104:107], v[88:91], v[72:87]
    ds_read_b128 v[104:107], v112 offset:2048
    v_exp_f32 v51, v51
    v_cvt_pk_bf16_f32 v92, v48, v49
    v_cvt_pk_bf16_f32 v93, v50, v51
    s_add_u32 m0, s76, 0
    s_nop 0
    buffer_load_dwordx4 v114, s[24:27], s51 offen offset:3072 sc1 lds
    v_exp_f32 v52, v52
    v_exp_f32 v53, v53
    v_exp_f32 v54, v54
    v_exp_f32 v55, v55
    v_cvt_pk_bf16_f32 v94, v52, v53
    v_cvt_pk_bf16_f32 v95, v54, v55
    v_mfma_f32_32x32x16_bf16 v[40:55], v[96:99], v[16:19], 0
    ds_read_b128 v[96:99], v112 offset:8192
    v_exp_f32 v24, v24
    v_exp_f32 v25, v25
    v_exp_f32 v26, v26
    v_exp_f32 v27, v27
    v_mfma_f32_32x32x16_bf16 v[72:87], v[108:111], v[92:95], v[72:87]
    ds_read_b128 v[108:111], v112 offset:3072
    v_cvt_pk_bf16_f32 v88, v24, v25
    v_cvt_pk_bf16_f32 v89, v26, v27
    v_exp_f32 v28, v28
    v_exp_f32 v29, v29
    v_exp_f32 v30, v30
    v_mfma_f32_32x32x16_bf16 v[40:55], v[100:103], v[20:23], v[40:55]
    ds_read_b128 v[100:103], v112 offset:9216
    v_exp_f32 v31, v31
    v_cvt_pk_bf16_f32 v90, v28, v29
    v_cvt_pk_bf16_f32 v91, v30, v31
    v_exp_f32 v32, v32
    v_exp_f32 v33, v33
    v_exp_f32 v34, v34
    s_waitcnt lgkmcnt(3)
    v_mfma_f32_32x32x16_bf16 v[56:71], v[104:107], v[88:91], v[56:71]
    v_exp_f32 v35, v35
    v_cvt_pk_bf16_f32 v92, v32, v33
    v_cvt_pk_bf16_f32 v93, v34, v35
    s_mov_b32 m0, s45
    s_add_u32 s59, s46, 75264
    buffer_load_dwordx4 v116, s[16:19], s59 offen offset:0 lds
    v_exp_f32 v36, v36
    v_exp_f32 v37, v37
    v_exp_f32 v38, v38
    v_exp_f32 v39, v39
    v_cvt_pk_bf16_f32 v94, v36, v37
    v_cvt_pk_bf16_f32 v95, v38, v39
    s_waitcnt lgkmcnt(0)
    v_mfma_f32_32x32x16_bf16 v[24:39], v[96:99], v[8:11], 0
    v_exp_f32 v40, v40
    v_exp_f32 v41, v41
    v_exp_f32 v42, v42
    v_exp_f32 v43, v43
    v_mfma_f32_32x32x16_bf16 v[56:71], v[108:111], v[92:95], v[56:71]
    v_cvt_pk_bf16_f32 v88, v40, v41
    v_cvt_pk_bf16_f32 v89, v42, v43
    v_exp_f32 v44, v44
    v_exp_f32 v45, v45
    v_exp_f32 v46, v46
    v_mfma_f32_32x32x16_bf16 v[24:39], v[100:103], v[12:15], v[24:39]
    v_exp_f32 v47, v47
    v_cvt_pk_bf16_f32 v90, v44, v45
    v_cvt_pk_bf16_f32 v91, v46, v47
    s_mov_b32 m0, s45
    s_add_u32 s59, s46, 75072
    buffer_load_dwordx4 v116, s[16:19], s59 offen offset:1088 lds
    v_exp_f32 v48, v48
    v_exp_f32 v49, v49
    v_exp_f32 v50, v50
    v_mfma_f32_32x32x16_bf16 v[72:87], v[104:107], v[88:91], v[72:87]
    ds_read_b128 v[104:107], v112 offset:10240
    v_exp_f32 v51, v51
    v_cvt_pk_bf16_f32 v92, v48, v49
    v_cvt_pk_bf16_f32 v93, v50, v51
    s_mov_b32 m0, s45
    s_add_u32 s59, s46, 74880
    buffer_load_dwordx4 v116, s[16:19], s59 offen offset:2176 lds
    v_exp_f32 v52, v52
    v_exp_f32 v53, v53
    v_exp_f32 v54, v54
    v_exp_f32 v55, v55
    v_cvt_pk_bf16_f32 v94, v52, v53
    v_cvt_pk_bf16_f32 v95, v54, v55
    s_setprio 0
    v_mfma_f32_32x32x16_bf16 v[40:55], v[96:99], v[16:19], 0
    ds_read_b128 v[96:99], v112 offset:16384
    v_exp_f32 v24, v24
    v_exp_f32 v25, v25
    v_exp_f32 v26, v26
    v_exp_f32 v27, v27
    v_mfma_f32_32x32x16_bf16 v[72:87], v[108:111], v[92:95], v[72:87]
    ds_read_b128 v[108:111], v112 offset:11264
    v_cvt_pk_bf16_f32 v88, v24, v25
    v_cvt_pk_bf16_f32 v89, v26, v27
    v_exp_f32 v28, v28
    v_exp_f32 v29, v29
    v_exp_f32 v30, v30
    v_mfma_f32_32x32x16_bf16 v[40:55], v[100:103], v[20:23], v[40:55]
    ds_read_b128 v[100:103], v112 offset:17408
    v_exp_f32 v31, v31
    v_cvt_pk_bf16_f32 v90, v28, v29
    v_cvt_pk_bf16_f32 v91, v30, v31
    s_mov_b32 m0, s45
    s_add_u32 s59, s46, 74688
    buffer_load_dwordx4 v116, s[16:19], s59 offen offset:3264 lds
    v_exp_f32 v32, v32
    v_exp_f32 v33, v33
    v_exp_f32 v34, v34
    s_waitcnt lgkmcnt(3)
    v_mfma_f32_32x32x16_bf16 v[56:71], v[104:107], v[88:91], v[56:71]
    v_exp_f32 v35, v35
    v_cvt_pk_bf16_f32 v92, v32, v33
    v_cvt_pk_bf16_f32 v93, v34, v35
    v_exp_f32 v36, v36
    v_exp_f32 v37, v37
    v_exp_f32 v38, v38
    v_exp_f32 v39, v39
    v_cvt_pk_bf16_f32 v94, v36, v37
    v_cvt_pk_bf16_f32 v95, v38, v39
    s_waitcnt lgkmcnt(0)
    v_mfma_f32_32x32x16_bf16 v[24:39], v[96:99], v[8:11], 0
    v_exp_f32 v40, v40
    v_exp_f32 v41, v41
    v_exp_f32 v42, v42
    v_exp_f32 v43, v43
    v_mfma_f32_32x32x16_bf16 v[56:71], v[108:111], v[92:95], v[56:71]
    v_cvt_pk_bf16_f32 v88, v40, v41
    v_cvt_pk_bf16_f32 v89, v42, v43
    v_exp_f32 v44, v44
    v_exp_f32 v45, v45
    v_exp_f32 v46, v46
    v_mfma_f32_32x32x16_bf16 v[24:39], v[100:103], v[12:15], v[24:39]
    v_exp_f32 v47, v47
    v_cvt_pk_bf16_f32 v90, v44, v45
    v_cvt_pk_bf16_f32 v91, v46, v47
    v_exp_f32 v48, v48
    v_exp_f32 v49, v49
    v_exp_f32 v50, v50
    v_mfma_f32_32x32x16_bf16 v[72:87], v[104:107], v[88:91], v[72:87]
    ds_read_b128 v[104:107], v112 offset:18432
    v_exp_f32 v51, v51
    v_cvt_pk_bf16_f32 v92, v48, v49
    v_cvt_pk_bf16_f32 v93, v50, v51
    v_exp_f32 v52, v52
    v_exp_f32 v53, v53
    v_exp_f32 v54, v54
    v_exp_f32 v55, v55
    v_cvt_pk_bf16_f32 v94, v52, v53
    v_cvt_pk_bf16_f32 v95, v54, v55
    v_mfma_f32_32x32x16_bf16 v[40:55], v[96:99], v[16:19], 0
    ds_read_b128 v[96:99], v112 offset:24576
    v_exp_f32 v24, v24
    v_exp_f32 v25, v25
    v_exp_f32 v26, v26
    v_exp_f32 v27, v27
    v_mfma_f32_32x32x16_bf16 v[72:87], v[108:111], v[92:95], v[72:87]
    ds_read_b128 v[108:111], v112 offset:19456
    v_cvt_pk_bf16_f32 v88, v24, v25
    v_cvt_pk_bf16_f32 v89, v26, v27
    v_exp_f32 v28, v28
    v_exp_f32 v29, v29
    v_exp_f32 v30, v30
    v_mfma_f32_32x32x16_bf16 v[40:55], v[100:103], v[20:23], v[40:55]
    ds_read_b128 v[100:103], v112 offset:25600
    v_exp_f32 v31, v31
    v_cvt_pk_bf16_f32 v90, v28, v29
    v_cvt_pk_bf16_f32 v91, v30, v31
    v_exp_f32 v32, v32
    v_exp_f32 v33, v33
    v_exp_f32 v34, v34
    s_waitcnt lgkmcnt(3)
    v_mfma_f32_32x32x16_bf16 v[56:71], v[104:107], v[88:91], v[56:71]
    v_exp_f32 v35, v35
    v_cvt_pk_bf16_f32 v92, v32, v33
    v_cvt_pk_bf16_f32 v93, v34, v35
    v_exp_f32 v36, v36
    v_exp_f32 v37, v37
    v_exp_f32 v38, v38
    v_exp_f32 v39, v39
    v_cvt_pk_bf16_f32 v94, v36, v37
    v_cvt_pk_bf16_f32 v95, v38, v39
    s_waitcnt lgkmcnt(0)
    v_mfma_f32_32x32x16_bf16 v[24:39], v[96:99], v[8:11], 0
    v_exp_f32 v40, v40
    v_exp_f32 v41, v41
    v_exp_f32 v42, v42
    v_exp_f32 v43, v43
    v_mfma_f32_32x32x16_bf16 v[56:71], v[108:111], v[92:95], v[56:71]
    v_cvt_pk_bf16_f32 v88, v40, v41
    v_cvt_pk_bf16_f32 v89, v42, v43
    v_exp_f32 v44, v44
    v_exp_f32 v45, v45
    v_exp_f32 v46, v46
    v_mfma_f32_32x32x16_bf16 v[24:39], v[100:103], v[12:15], v[24:39]
    v_exp_f32 v47, v47
    v_cvt_pk_bf16_f32 v90, v44, v45
    v_cvt_pk_bf16_f32 v91, v46, v47
    v_exp_f32 v48, v48
    v_exp_f32 v49, v49
    v_exp_f32 v50, v50
    v_mfma_f32_32x32x16_bf16 v[72:87], v[104:107], v[88:91], v[72:87]
    ds_read_b128 v[104:107], v112 offset:26624
    v_exp_f32 v51, v51
    v_cvt_pk_bf16_f32 v92, v48, v49
    v_cvt_pk_bf16_f32 v93, v50, v51
    v_exp_f32 v52, v52
    v_exp_f32 v53, v53
    v_exp_f32 v54, v54
    v_exp_f32 v55, v55
    v_cvt_pk_bf16_f32 v94, v52, v53
    v_cvt_pk_bf16_f32 v95, v54, v55
    s_waitcnt vmcnt(0) lgkmcnt(0)
    s_barrier
    ds_read_b64_tr_b16 a[96:97], v117 offset:0
    ds_read_b64_tr_b16 a[98:99], v117 offset:512
    ds_read_b64_tr_b16 a[100:101], v117 offset:64
    ds_read_b64_tr_b16 a[102:103], v117 offset:576
    s_setprio 1
    v_mfma_f32_32x32x16_bf16 v[40:55], v[96:99], v[16:19], 0
    ds_read_b128 v[96:99], v120 offset:0
    v_exp_f32 v24, v24
    v_exp_f32 v25, v25
    v_exp_f32 v26, v26
    v_exp_f32 v27, v27
    v_mfma_f32_32x32x16_bf16 v[72:87], v[108:111], v[92:95], v[72:87]
    ds_read_b128 v[108:111], v112 offset:27648
    v_cvt_pk_bf16_f32 v88, v24, v25
    v_cvt_pk_bf16_f32 v89, v26, v27
    v_exp_f32 v28, v28
    v_exp_f32 v29, v29
    v_exp_f32 v30, v30
    v_mfma_f32_32x32x16_bf16 v[40:55], v[100:103], v[20:23], v[40:55]
    ds_read_b128 v[100:103], v120 offset:1024
    v_exp_f32 v31, v31
    v_cvt_pk_bf16_f32 v90, v28, v29
    v_cvt_pk_bf16_f32 v91, v30, v31
    v_exp_f32 v32, v32
    v_exp_f32 v33, v33
    v_exp_f32 v34, v34
    s_waitcnt lgkmcnt(3)
    v_mfma_f32_32x32x16_bf16 v[56:71], v[104:107], v[88:91], v[56:71]
    v_exp_f32 v35, v35
    v_cvt_pk_bf16_f32 v92, v32, v33
    v_cvt_pk_bf16_f32 v93, v34, v35
    v_exp_f32 v36, v36
    v_exp_f32 v37, v37
    v_exp_f32 v38, v38
    v_exp_f32 v39, v39
    v_cvt_pk_bf16_f32 v94, v36, v37
    v_cvt_pk_bf16_f32 v95, v38, v39
    s_waitcnt lgkmcnt(0)
    v_mfma_f32_32x32x16_bf16 v[24:39], v[96:99], v[8:11], 0
    v_exp_f32 v40, v40
    v_exp_f32 v41, v41
    v_exp_f32 v42, v42
    v_exp_f32 v43, v43
    v_mfma_f32_32x32x16_bf16 v[56:71], v[108:111], v[92:95], v[56:71]
    v_cvt_pk_bf16_f32 v88, v40, v41
    v_cvt_pk_bf16_f32 v89, v42, v43
    v_exp_f32 v44, v44
    v_exp_f32 v45, v45
    v_exp_f32 v46, v46
    v_mfma_f32_32x32x16_bf16 v[24:39], v[100:103], v[12:15], v[24:39]
    v_exp_f32 v47, v47
    v_cvt_pk_bf16_f32 v90, v44, v45
    v_cvt_pk_bf16_f32 v91, v46, v47
    ds_read_b64_tr_b16 a[104:105], v117 offset:128
    ds_read_b64_tr_b16 a[106:107], v117 offset:640
    ds_read_b64_tr_b16 a[108:109], v117 offset:192
    ds_read_b64_tr_b16 a[110:111], v117 offset:704
    v_exp_f32 v48, v48
    v_exp_f32 v49, v49
    v_exp_f32 v50, v50
    v_mfma_f32_32x32x16_bf16 v[72:87], v[104:107], v[88:91], v[72:87]
    ds_read_b128 v[104:107], v120 offset:2048
    v_exp_f32 v51, v51
    v_cvt_pk_bf16_f32 v92, v48, v49
    v_cvt_pk_bf16_f32 v93, v50, v51
    v_exp_f32 v52, v52
    v_exp_f32 v53, v53
    v_exp_f32 v54, v54
    v_exp_f32 v55, v55
    v_cvt_pk_bf16_f32 v94, v52, v53
    v_cvt_pk_bf16_f32 v95, v54, v55
    v_mfma_f32_32x32x16_bf16 v[40:55], v[96:99], v[16:19], 0
    ds_read_b128 v[96:99], v120 offset:8192
    v_exp_f32 v24, v24
    v_exp_f32 v25, v25
    v_exp_f32 v26, v26
    v_exp_f32 v27, v27
    v_mfma_f32_32x32x16_bf16 v[72:87], v[108:111], v[92:95], v[72:87]
    ds_read_b128 v[108:111], v120 offset:3072
    v_cvt_pk_bf16_f32 v88, v24, v25
    v_cvt_pk_bf16_f32 v89, v26, v27
    v_exp_f32 v28, v28
    v_exp_f32 v29, v29
    v_exp_f32 v30, v30
    v_mfma_f32_32x32x16_bf16 v[40:55], v[100:103], v[20:23], v[40:55]
    ds_read_b128 v[100:103], v120 offset:9216
    v_exp_f32 v31, v31
    v_cvt_pk_bf16_f32 v90, v28, v29
    v_cvt_pk_bf16_f32 v91, v30, v31
    v_exp_f32 v32, v32
    v_exp_f32 v33, v33
    v_exp_f32 v34, v34
    s_waitcnt lgkmcnt(3)
    v_mfma_f32_32x32x16_bf16 v[56:71], v[104:107], v[88:91], v[56:71]
    v_exp_f32 v35, v35
    v_cvt_pk_bf16_f32 v92, v32, v33
    v_cvt_pk_bf16_f32 v93, v34, v35
    s_mov_b32 m0, s45
    s_add_u32 s59, s46, 89600
    buffer_load_dwordx4 v116, s[16:19], s59 offen offset:0 lds
    v_exp_f32 v36, v36
    v_exp_f32 v37, v37
    v_exp_f32 v38, v38
    v_exp_f32 v39, v39
    v_cvt_pk_bf16_f32 v94, v36, v37
    v_cvt_pk_bf16_f32 v95, v38, v39
    s_waitcnt lgkmcnt(0)
    v_mfma_f32_32x32x16_bf16 v[24:39], v[96:99], v[8:11], 0
    v_exp_f32 v40, v40
    v_exp_f32 v41, v41
    v_exp_f32 v42, v42
    v_exp_f32 v43, v43
    v_mfma_f32_32x32x16_bf16 v[56:71], v[108:111], v[92:95], v[56:71]
    v_cvt_pk_bf16_f32 v88, v40, v41
    v_cvt_pk_bf16_f32 v89, v42, v43
    v_exp_f32 v44, v44
    v_exp_f32 v45, v45
    v_exp_f32 v46, v46
    v_mfma_f32_32x32x16_bf16 v[24:39], v[100:103], v[12:15], v[24:39]
    v_exp_f32 v47, v47
    v_cvt_pk_bf16_f32 v90, v44, v45
    v_cvt_pk_bf16_f32 v91, v46, v47
    s_mov_b32 m0, s45
    s_add_u32 s59, s46, 89408
    buffer_load_dwordx4 v116, s[16:19], s59 offen offset:1088 lds
    v_exp_f32 v48, v48
    v_exp_f32 v49, v49
    v_exp_f32 v50, v50
    v_mfma_f32_32x32x16_bf16 v[72:87], v[104:107], v[88:91], v[72:87]
    ds_read_b128 v[104:107], v120 offset:10240
    v_exp_f32 v51, v51
    v_cvt_pk_bf16_f32 v92, v48, v49
    v_cvt_pk_bf16_f32 v93, v50, v51
    s_mov_b32 m0, s45
    s_add_u32 s59, s46, 89216
    buffer_load_dwordx4 v116, s[16:19], s59 offen offset:2176 lds
    v_exp_f32 v52, v52
    v_exp_f32 v53, v53
    v_exp_f32 v54, v54
    v_exp_f32 v55, v55
    v_cvt_pk_bf16_f32 v94, v52, v53
    v_cvt_pk_bf16_f32 v95, v54, v55
    s_setprio 0
    v_mfma_f32_32x32x16_bf16 v[40:55], v[96:99], v[16:19], 0
    ds_read_b128 v[96:99], v120 offset:16384
    v_exp_f32 v24, v24
    v_exp_f32 v25, v25
    v_exp_f32 v26, v26
    v_exp_f32 v27, v27
    v_mfma_f32_32x32x16_bf16 v[72:87], v[108:111], v[92:95], v[72:87]
    ds_read_b128 v[108:111], v120 offset:11264
    v_cvt_pk_bf16_f32 v88, v24, v25
    v_cvt_pk_bf16_f32 v89, v26, v27
    v_exp_f32 v28, v28
    v_exp_f32 v29, v29
    v_exp_f32 v30, v30
    v_mfma_f32_32x32x16_bf16 v[40:55], v[100:103], v[20:23], v[40:55]
    ds_read_b128 v[100:103], v120 offset:17408
    v_exp_f32 v31, v31
    v_cvt_pk_bf16_f32 v90, v28, v29
    v_cvt_pk_bf16_f32 v91, v30, v31
    s_mov_b32 m0, s45
    s_add_u32 s59, s46, 89024
    buffer_load_dwordx4 v116, s[16:19], s59 offen offset:3264 lds
    v_exp_f32 v32, v32
    v_exp_f32 v33, v33
    v_exp_f32 v34, v34
    s_waitcnt lgkmcnt(3)
    v_mfma_f32_32x32x16_bf16 v[56:71], v[104:107], v[88:91], v[56:71]
    v_exp_f32 v35, v35
    v_cvt_pk_bf16_f32 v92, v32, v33
    v_cvt_pk_bf16_f32 v93, v34, v35
    v_exp_f32 v36, v36
    v_exp_f32 v37, v37
    v_exp_f32 v38, v38
    v_exp_f32 v39, v39
    v_cvt_pk_bf16_f32 v94, v36, v37
    v_cvt_pk_bf16_f32 v95, v38, v39
    s_waitcnt lgkmcnt(0)
    v_mfma_f32_32x32x16_bf16 v[24:39], v[96:99], v[8:11], 0
    v_exp_f32 v40, v40
    v_exp_f32 v41, v41
    v_exp_f32 v42, v42
    v_exp_f32 v43, v43
    v_mfma_f32_32x32x16_bf16 v[56:71], v[108:111], v[92:95], v[56:71]
    v_cvt_pk_bf16_f32 v88, v40, v41
    v_cvt_pk_bf16_f32 v89, v42, v43
    v_exp_f32 v44, v44
    v_exp_f32 v45, v45
    v_exp_f32 v46, v46
    v_mfma_f32_32x32x16_bf16 v[24:39], v[100:103], v[12:15], v[24:39]
    v_exp_f32 v47, v47
    v_cvt_pk_bf16_f32 v90, v44, v45
    v_cvt_pk_bf16_f32 v91, v46, v47
    v_exp_f32 v48, v48
    v_exp_f32 v49, v49
    v_exp_f32 v50, v50
    v_mfma_f32_32x32x16_bf16 v[72:87], v[104:107], v[88:91], v[72:87]
    ds_read_b128 v[104:107], v120 offset:18432
    v_exp_f32 v51, v51
    v_cvt_pk_bf16_f32 v92, v48, v49
    v_cvt_pk_bf16_f32 v93, v50, v51
    v_exp_f32 v52, v52
    v_exp_f32 v53, v53
    v_exp_f32 v54, v54
    v_exp_f32 v55, v55
    v_cvt_pk_bf16_f32 v94, v52, v53
    v_cvt_pk_bf16_f32 v95, v54, v55
    v_mfma_f32_32x32x16_bf16 v[40:55], v[96:99], v[16:19], 0
    ds_read_b128 v[96:99], v120 offset:24576
    v_exp_f32 v24, v24
    v_exp_f32 v25, v25
    v_exp_f32 v26, v26
    v_exp_f32 v27, v27
    v_mfma_f32_32x32x16_bf16 v[72:87], v[108:111], v[92:95], v[72:87]
    ds_read_b128 v[108:111], v120 offset:19456
    v_cvt_pk_bf16_f32 v88, v24, v25
    v_cvt_pk_bf16_f32 v89, v26, v27
    v_exp_f32 v28, v28
    v_exp_f32 v29, v29
    v_exp_f32 v30, v30
    v_mfma_f32_32x32x16_bf16 v[40:55], v[100:103], v[20:23], v[40:55]
    ds_read_b128 v[100:103], v120 offset:25600
    v_exp_f32 v31, v31
    v_cvt_pk_bf16_f32 v90, v28, v29
    v_cvt_pk_bf16_f32 v91, v30, v31
    v_exp_f32 v32, v32
    v_exp_f32 v33, v33
    v_exp_f32 v34, v34
    s_waitcnt lgkmcnt(3)
    v_mfma_f32_32x32x16_bf16 v[56:71], v[104:107], v[88:91], v[56:71]
    v_exp_f32 v35, v35
    v_cvt_pk_bf16_f32 v92, v32, v33
    v_cvt_pk_bf16_f32 v93, v34, v35
    v_exp_f32 v36, v36
    v_exp_f32 v37, v37
    v_exp_f32 v38, v38
    v_exp_f32 v39, v39
    v_cvt_pk_bf16_f32 v94, v36, v37
    v_cvt_pk_bf16_f32 v95, v38, v39
    s_waitcnt lgkmcnt(0)
    v_mfma_f32_32x32x16_bf16 v[24:39], v[96:99], v[8:11], 0
    v_exp_f32 v40, v40
    v_exp_f32 v41, v41
    v_exp_f32 v42, v42
    v_exp_f32 v43, v43
    v_mfma_f32_32x32x16_bf16 v[56:71], v[108:111], v[92:95], v[56:71]
    v_cvt_pk_bf16_f32 v88, v40, v41
    v_cvt_pk_bf16_f32 v89, v42, v43
    v_exp_f32 v44, v44
    v_exp_f32 v45, v45
    v_exp_f32 v46, v46
    v_mfma_f32_32x32x16_bf16 v[24:39], v[100:103], v[12:15], v[24:39]
    v_exp_f32 v47, v47
    v_cvt_pk_bf16_f32 v90, v44, v45
    v_cvt_pk_bf16_f32 v91, v46, v47
    v_exp_f32 v48, v48
    v_exp_f32 v49, v49
    v_exp_f32 v50, v50
    v_mfma_f32_32x32x16_bf16 v[72:87], v[104:107], v[88:91], v[72:87]
    ds_read_b128 v[104:107], v120 offset:26624
    v_exp_f32 v51, v51
    v_cvt_pk_bf16_f32 v92, v48, v49
    v_cvt_pk_bf16_f32 v93, v50, v51
    v_exp_f32 v52, v52
    v_exp_f32 v53, v53
    v_exp_f32 v54, v54
    v_exp_f32 v55, v55
    v_cvt_pk_bf16_f32 v94, v52, v53
    v_cvt_pk_bf16_f32 v95, v54, v55
    s_waitcnt vmcnt(0) lgkmcnt(0)
    s_barrier
    ds_read_b64_tr_b16 a[112:113], v117 offset:0
    ds_read_b64_tr_b16 a[114:115], v117 offset:512
    ds_read_b64_tr_b16 a[116:117], v117 offset:64
    ds_read_b64_tr_b16 a[118:119], v117 offset:576
    s_setprio 1
    v_mfma_f32_32x32x16_bf16 v[40:55], v[96:99], v[16:19], 0
    ds_read_b128 v[96:99], v120 offset:32768
    v_exp_f32 v24, v24
    v_exp_f32 v25, v25
    v_exp_f32 v26, v26
    v_exp_f32 v27, v27
    v_mfma_f32_32x32x16_bf16 v[72:87], v[108:111], v[92:95], v[72:87]
    ds_read_b128 v[108:111], v120 offset:27648
    v_cvt_pk_bf16_f32 v88, v24, v25
    v_cvt_pk_bf16_f32 v89, v26, v27
    v_exp_f32 v28, v28
    v_exp_f32 v29, v29
    v_exp_f32 v30, v30
    v_mfma_f32_32x32x16_bf16 v[40:55], v[100:103], v[20:23], v[40:55]
    ds_read_b128 v[100:103], v120 offset:33792
    v_exp_f32 v31, v31
    v_cvt_pk_bf16_f32 v90, v28, v29
    v_cvt_pk_bf16_f32 v91, v30, v31
    v_exp_f32 v32, v32
    v_exp_f32 v33, v33
    v_exp_f32 v34, v34
    s_waitcnt lgkmcnt(3)
    v_mfma_f32_32x32x16_bf16 v[56:71], v[104:107], v[88:91], v[56:71]
    v_exp_f32 v35, v35
    v_cvt_pk_bf16_f32 v92, v32, v33
    v_cvt_pk_bf16_f32 v93, v34, v35
    v_exp_f32 v36, v36
    v_exp_f32 v37, v37
    v_exp_f32 v38, v38
    v_exp_f32 v39, v39
    v_cvt_pk_bf16_f32 v94, v36, v37
    v_cvt_pk_bf16_f32 v95, v38, v39
    s_waitcnt lgkmcnt(0)
    v_exp_f32 v40, v40
    v_exp_f32 v41, v41
    v_exp_f32 v42, v42
    v_exp_f32 v43, v43
    v_mfma_f32_32x32x16_bf16 v[56:71], v[108:111], v[92:95], v[56:71]
    v_cvt_pk_bf16_f32 v88, v40, v41
    v_cvt_pk_bf16_f32 v89, v42, v43
    v_exp_f32 v44, v44
    v_exp_f32 v45, v45
    v_exp_f32 v46, v46
    v_exp_f32 v47, v47
    v_cvt_pk_bf16_f32 v90, v44, v45
    v_cvt_pk_bf16_f32 v91, v46, v47
    ds_read_b64_tr_b16 a[120:121], v117 offset:128
    ds_read_b64_tr_b16 a[122:123], v117 offset:640
    ds_read_b64_tr_b16 a[124:125], v117 offset:192
    ds_read_b64_tr_b16 a[126:127], v117 offset:704
    v_exp_f32 v48, v48
    v_exp_f32 v49, v49
    v_exp_f32 v50, v50
    v_mfma_f32_32x32x16_bf16 v[72:87], v[104:107], v[88:91], v[72:87]
    s_xor_b32 s62, s76, 16384
    s_add_u32 s62, s62, 126976
    v_add_u32 v4, s62, v3
    ds_write_b128 v4, v[56:59] offset:0
    ds_write_b128 v4, v[60:63] offset:1024
    ds_write_b128 v4, v[64:67] offset:2048
    ds_write_b128 v4, v[68:71] offset:3072
    v_exp_f32 v51, v51
    v_cvt_pk_bf16_f32 v92, v48, v49
    v_cvt_pk_bf16_f32 v93, v50, v51
    v_exp_f32 v52, v52
    v_exp_f32 v53, v53
    v_exp_f32 v54, v54
    v_exp_f32 v55, v55
    v_cvt_pk_bf16_f32 v94, v52, v53
    v_cvt_pk_bf16_f32 v95, v54, v55
    s_nop 0
L_POST:
    s_lshr_b32 s64, s56, 2
    v_mfma_f32_32x32x16_bf16 v[72:87], v[108:111], v[92:95], v[72:87]
    s_lshl_b32 s62, s57, 3
    s_add_u32 s64, s64, s62
    s_lshl_b32 s62, s64, 3
    s_add_u32 s62, s62, s58
    s_mul_i32 s62, s62, 3584
    v_lshrrev_b32 v6, 4, v2
    v_mul_u32_u24 v6, 896, v6
    v_and_b32 v7, 15, v2
    v_lshlrev_b32 v7, 4, v7
    v_add_u32 v6, v6, v7
    s_waitcnt lgkmcnt(0)
    buffer_load_dwordx4 v[40:43], v6, s[4:7], s62 offen offset:0
    buffer_load_dwordx4 v[44:47], v6, s[4:7], s62 offen offset:256
    buffer_load_dwordx4 v[48:51], v6, s[4:7], s62 offen offset:512
    buffer_load_dwordx4 v[52:55], v6, s[4:7], s62 offen offset:768
    buffer_load_dwordx4 v[96:99], v7, s[20:23], 0 offen offset:0
    buffer_load_dwordx4 v[100:103], v7, s[20:23], 0 offen offset:256
    buffer_load_dwordx4 v[104:107], v7, s[20:23], 0 offen offset:512
    buffer_load_dwordx4 v[108:111], v7, s[20:23], 0 offen offset:768
    v_add_u32 v5, s65, v3
    v_mov_b32 v6, 0x53000000
    v_max_f32 v7, v68, v84
    v_add_f32 v4, v68, v84
    v_cmp_nlt_f32 vcc, v7, v6
    v_cmp_u_f32 s[62:63], v4, v4
    v_mov_b32 v6, 159744
    v_mov_b32 v7, 1
    s_nop 1
    s_or_b32 s62, vcc_hi, s63
    s_cbranch_scc0 L_NOVOTE
    ds_write_b32 v6, v7
L_NOVOTE:
    s_waitcnt lgkmcnt(0)
    s_barrier
    ds_read_b32 v7, v6
    ds_read_b128 v[24:27], v5 offset:0
    ds_read_b128 v[28:31], v5 offset:1024
    ds_read_b128 v[32:35], v5 offset:2048
    ds_read_b128 v[36:39], v5 offset:3072
    s_cmp_lg_u32 s77, 0
    s_cbranch_scc1 L_FIN
    s_waitcnt lgkmcnt(4)
    v_readfirstlane_b32 s62, v7
    s_nop 3
    s_cmp_lg_u32 s62, 0
    s_cbranch_scc1 L_FALLBACK
L_FIN:
    s_waitcnt lgkmcnt(0)
    v_add_f32 v72, v72, v24
    v_add_f32 v73, v73, v25
    v_add_f32 v74, v74, v26
    v_add_f32 v75, v75, v27
    v_add_f32 v76, v76, v28
    v_add_f32 v77, v77, v29
    v_add_f32 v78, v78, v30
    v_add_f32 v79, v79, v31
    v_add_f32 v80, v80, v32
    v_add_f32 v81, v81, v33
    v_add_f32 v82, v82, v34
    v_add_f32 v83, v83, v35
    v_add_f32 v84, v84, v36
    v_add_f32 v85, v85, v37
    v_add_f32 v86, v86, v38
    v_add_f32 v87, v87, v39
    v_mov_b32 v4, v84
    v_mov_b32 v5, v84
    s_lshl_b32 s62, s57, 3
    s_add_u32 s62, s62, s44
    v_permlane32_swap_b32 v4, v5
    s_lshl_b32 s62, s62, 5
    s_add_u32 s62, s62, s56
    v_rcp_f32 v4, v5
    s_lshl_b32 s63, s62, 11
    s_add_u32 s63, s63, 8388608
    v_mul_f32 v72, v72, v4
    v_mul_f32 v73, v73, v4
    v_mul_f32 v74, v74, v4
    v_mul_f32 v75, v75, v4
    v_mul_f32 v76, v76, v4
    v_mul_f32 v77, v77, v4
    v_mul_f32 v78, v78, v4
    v_mul_f32 v79, v79, v4
    v_cvt_pk_bf16_f32 v88, v72, v73
    v_cvt_pk_bf16_f32 v89, v74, v75
    v_cvt_pk_bf16_f32 v90, v76, v77
    v_cvt_pk_bf16_f32 v91, v78, v79
    buffer_store_dwordx4 v[88:91], v3, s[12:15], s63 offen sc1
    v_mul_f32 v80, v80, v4
    v_mul_f32 v81, v81, v4
    v_mul_f32 v82, v82, v4
    v_mul_f32 v83, v83, v4
    v_mul_f32 v84, v84, v4
    v_mul_f32 v85, v85, v4
    v_mul_f32 v86, v86, v4
    v_mul_f32 v87, v87, v4
    v_cvt_pk_bf16_f32 v92, v80, v81
    v_cvt_pk_bf16_f32 v93, v82, v83
    v_cvt_pk_bf16_f32 v94, v84, v85
    v_cvt_pk_bf16_f32 v95, v86, v87
    s_mov_b32 exec_lo, 0
    v_mov_b32 v94, 0
    v_mov_b32 v95, 0
    s_mov_b32 exec_lo, -1
    buffer_store_dwordx4 v[92:95], v3, s[12:15], s63 offen offset:1024 sc1
    s_lshl_b32 s63, s62, 3
    s_add_u32 s63, s63, 12648448
    s_lshl_b32 s62, s64, 5
    s_lshl_b32 s59, s58, 2
    s_add_u32 s62, s62, s59
    s_lshl_b32 s59, s62, 3
    s_add_u32 s59, s59, 12648448
    v_and_b32 v7, 3, v2
    v_lshl_add_u32 v115, v7, 3, s59
    s_lshl_b32 s62, s62, 11
    s_add_u32 s62, s62, 8388608
    v_mov_b32 v4, 0
    v_mov_b32 v5, 0
    s_waitcnt vmcnt(2)
    v_dot2c_f32_bf16 v4, v40, v96
    v_dot2c_f32_bf16 v5, v41, v97
    v_dot2c_f32_bf16 v4, v42, v98
    v_dot2c_f32_bf16 v5, v43, v99
    v_dot2c_f32_bf16 v4, v44, v100
    v_dot2c_f32_bf16 v5, v45, v101
    v_dot2c_f32_bf16 v4, v46, v102
    v_dot2c_f32_bf16 v5, v47, v103
    v_dot2c_f32_bf16 v4, v48, v104
    v_dot2c_f32_bf16 v5, v49, v105
    v_dot2c_f32_bf16 v4, v50, v106
    v_dot2c_f32_bf16 v5, v51, v107
    v_dot2c_f32_bf16 v4, v52, v108
    v_dot2c_f32_bf16 v5, v53, v109
    v_dot2c_f32_bf16 v4, v54, v110
    v_dot2c_f32_bf16 v5, v55, v111
    v_lshrrev_b32 v6, 4, v2
    v_lshlrev_b32 v6, 2, v6
    s_lshl_b32 s59, s58, 4
    s_add_u32 s59, s59, 159808
    v_add_f32 v4, v4, v5
    v_add_u32 v6, s59, v6
    s_nop 1
    v_add_f32_dpp v4, v4, v4 row_ror:8 row_mask:0xf bank_mask:0xf
    s_nop 1
    v_add_f32_dpp v4, v4, v4 row_ror:4 row_mask:0xf bank_mask:0xf
    s_nop 1
    v_add_f32_dpp v4, v4, v4 row_ror:2 row_mask:0xf bank_mask:0xf
    s_nop 1
    v_add_f32_dpp v4, v4, v4 row_ror:1 row_mask:0xf bank_mask:0xf
    v_mul_f32 v4, 0xbfb8aa3b, v4
    v_exp_f32 v4, v4
    v_mov_b32 v7, 0
    v_add_f32 v4, 1.0, v4
    v_rcp_f32 v4, v4
    s_nop 0
    ds_write_b32 v6, v4
    s_waitcnt vmcnt(0)
    s_mov_b64 exec, 1
    buffer_store_dwordx2 v[118:119], v7, s[12:15], s63 offen sc1
    s_mov_b64 exec, -1
    s_waitcnt lgkmcnt(0)
    s_barrier
    v_and_b32 v5, 31, v2
    v_lshlrev_b32 v104, 2, v5
    v_add_u32 v104, 159808, v104
    ds_read_b32 v105, v104
    s_lshl_b32 s59, s64, 5
    v_add_u32 v5, s59, v5
    v_mul_u32_u24 v5, 896, v5
    v_lshrrev_b32 v6, 5, v2
    v_lshl_add_u32 v107, v6, 4, v5
    s_lshl_b32 s63, s3, 6
    s_lshl_b32 s59, s58, 5
    s_add_u32 s63, s63, s59
    s_and_b32 s64, s56, 2
    s_lshr_b32 s59, s58, 1
    s_add_u32 s64, s64, s59
    s_cmp_eq_u32 s64, 5
    s_cselect_b32 s64, 1073741824, s63
    s_lshl_b32 s59, s58, 11
    v_add_u32 v108, s59, v3
    v_add_u32 v109, 0x10000, v108
    s_lshl_b32 s59, s58, 14
    v_add_u32 v110, s59, v3
    s_mov_b32 s75, 200000
L_P3:
    buffer_load_dwordx2 v[124:125], v115, s[12:15], 0 offen sc1
    s_sub_u32 s75, s75, 1
    s_cmp_eq_u32 s75, 0
    s_cbranch_scc1 L_P3_OK
    s_waitcnt vmcnt(0)
    v_cmp_eq_u64 vcc, s[68:69], v[124:125]
    s_nop 3
    s_cmp_eq_u64 vcc, -1
    s_cbranch_scc0 L_P3
L_P3_OK:
    s_add_u32 s63, s62, 4096
    buffer_load_dwordx4 v[72:75], v3, s[12:15], s62 offen offset:0 sc1
    buffer_load_dwordx4 v[76:79], v3, s[12:15], s62 offen offset:1024 sc1
    buffer_load_dwordx4 v[80:83], v3, s[12:15], s62 offen offset:2048 sc1
    buffer_load_dwordx4 v[84:87], v3, s[12:15], s62 offen offset:3072 sc1
    buffer_load_dwordx4 v[88:91], v3, s[12:15], s63 offen offset:0 sc1
    buffer_load_dwordx4 v[92:95], v3, s[12:15], s63 offen offset:1024 sc1
    buffer_load_dwordx4 v[96:99], v3, s[12:15], s63 offen offset:2048 sc1
    buffer_load_dwordx4 v[100:103], v3, s[12:15], s63 offen offset:3072 sc1
    s_waitcnt vmcnt(7)
    v_mfma_f32_32x32x16_bf16 v[8:23], a[0:3], v[72:75], 0
    s_waitcnt vmcnt(6)
    v_mfma_f32_32x32x16_bf16 v[8:23], a[16:19], v[76:79], v[8:23]
    s_waitcnt vmcnt(5)
    v_mfma_f32_32x32x16_bf16 v[8:23], a[32:35], v[80:83], v[8:23]
    s_waitcnt vmcnt(4)
    v_mfma_f32_32x32x16_bf16 v[8:23], a[48:51], v[84:87], v[8:23]
    s_waitcnt vmcnt(3)
    v_mfma_f32_32x32x16_bf16 v[8:23], a[64:67], v[88:91], v[8:23]
    s_waitcnt vmcnt(2)
    v_mfma_f32_32x32x16_bf16 v[8:23], a[80:83], v[92:95], v[8:23]
    s_waitcnt vmcnt(1)
    v_mfma_f32_32x32x16_bf16 v[8:23], a[96:99], v[96:99], v[8:23]
    s_waitcnt vmcnt(0)
    v_mfma_f32_32x32x16_bf16 v[8:23], a[112:115], v[100:103], v[8:23]
    v_mfma_f32_32x32x16_bf16 v[24:39], a[4:7], v[72:75], 0
    s_nop 3
    v_mfma_f32_32x32x16_bf16 v[24:39], a[20:23], v[76:79], v[24:39]
    s_nop 3
    v_mfma_f32_32x32x16_bf16 v[24:39], a[36:39], v[80:83], v[24:39]
    v_mfma_f32_32x32x16_bf16 v[24:39], a[52:55], v[84:87], v[24:39]
    ds_write_b128 v108, v[8:11] offset:0
    v_mfma_f32_32x32x16_bf16 v[24:39], a[68:71], v[88:91], v[24:39]
    ds_write_b128 v108, v[12:15] offset:1024
    v_mfma_f32_32x32x16_bf16 v[24:39], a[84:87], v[92:95], v[24:39]
    ds_write_b128 v108, v[16:19] offset:16384
    v_mfma_f32_32x32x16_bf16 v[24:39], a[100:103], v[96:99], v[24:39]
    ds_write_b128 v108, v[20:23] offset:17408
    v_mfma_f32_32x32x16_bf16 v[24:39], a[116:119], v[100:103], v[24:39]
    v_mfma_f32_32x32x16_bf16 v[40:55], a[8:11], v[72:75], 0
    s_nop 3
    v_mfma_f32_32x32x16_bf16 v[40:55], a[24:27], v[76:79], v[40:55]
    s_nop 3
    v_mfma_f32_32x32x16_bf16 v[40:55], a[40:43], v[80:83], v[40:55]
    v_mfma_f32_32x32x16_bf16 v[40:55], a[56:59], v[84:87], v[40:55]
    ds_write_b128 v108, v[24:27] offset:32768
    v_mfma_f32_32x32x16_bf16 v[40:55], a[72:75], v[88:91], v[40:55]
    ds_write_b128 v108, v[28:31] offset:33792
    v_mfma_f32_32x32x16_bf16 v[40:55], a[88:91], v[92:95], v[40:55]
    ds_write_b128 v108, v[32:35] offset:49152
    v_mfma_f32_32x32x16_bf16 v[40:55], a[104:107], v[96:99], v[40:55]
    ds_write_b128 v108, v[36:39] offset:50176
    v_mfma_f32_32x32x16_bf16 v[40:55], a[120:123], v[100:103], v[40:55]
    v_mfma_f32_32x32x16_bf16 v[56:71], a[12:15], v[72:75], 0
    s_nop 3
    v_mfma_f32_32x32x16_bf16 v[56:71], a[28:31], v[76:79], v[56:71]
    s_nop 3
    v_mfma_f32_32x32x16_bf16 v[56:71], a[44:47], v[80:83], v[56:71]
    v_mfma_f32_32x32x16_bf16 v[56:71], a[60:63], v[84:87], v[56:71]
    ds_write_b128 v109, v[40:43] offset:0
    v_mfma_f32_32x32x16_bf16 v[56:71], a[76:79], v[88:91], v[56:71]
    ds_write_b128 v109, v[44:47] offset:1024
    v_mfma_f32_32x32x16_bf16 v[56:71], a[92:95], v[92:95], v[56:71]
    ds_write_b128 v109, v[48:51] offset:16384
    v_mfma_f32_32x32x16_bf16 v[56:71], a[108:111], v[96:99], v[56:71]
    ds_write_b128 v109, v[52:55] offset:17408
    v_mfma_f32_32x32x16_bf16 v[56:71], a[124:127], v[100:103], v[56:71]
    s_nop 11
    ds_write_b128 v109, v[56:59] offset:32768
    ds_write_b128 v109, v[60:63] offset:33792
    ds_write_b128 v109, v[64:67] offset:49152
    ds_write_b128 v109, v[68:71] offset:50176
    s_waitcnt lgkmcnt(0)
    s_barrier
    ds_read_b128 v[8:11], v110 offset:0
    ds_read_b128 v[12:15], v110 offset:1024
    ds_read_b128 v[16:19], v110 offset:2048
    ds_read_b128 v[20:23], v110 offset:3072
    ds_read_b128 v[24:27], v110 offset:4096
    ds_read_b128 v[28:31], v110 offset:5120
    ds_read_b128 v[32:35], v110 offset:6144
    ds_read_b128 v[36:39], v110 offset:7168
    ds_read_b128 v[40:43], v110 offset:8192
    ds_read_b128 v[44:47], v110 offset:9216
    ds_read_b128 v[48:51], v110 offset:10240
    ds_read_b128 v[52:55], v110 offset:11264
    ds_read_b128 v[56:59], v110 offset:12288
    ds_read_b128 v[60:63], v110 offset:13312
    ds_read_b128 v[64:67], v110 offset:14336
    ds_read_b128 v[68:71], v110 offset:15360
    v_sub_f32 v106, 1.0, v105
    s_waitcnt lgkmcnt(12)
    v_add_f32 v8, v8, v16
    v_add_f32 v9, v9, v17
    v_add_f32 v10, v10, v18
    v_add_f32 v11, v11, v19
    v_add_f32 v12, v12, v20
    v_add_f32 v13, v13, v21
    v_add_f32 v14, v14, v22
    v_add_f32 v15, v15, v23
    s_waitcnt lgkmcnt(8)
    v_add_f32 v24, v24, v32
    v_add_f32 v25, v25, v33
    v_add_f32 v26, v26, v34
    v_add_f32 v27, v27, v35
    v_add_f32 v28, v28, v36
    v_add_f32 v29, v29, v37
    v_add_f32 v30, v30, v38
    v_add_f32 v31, v31, v39
    v_add_f32 v8, v8, v24
    v_add_f32 v9, v9, v25
    v_add_f32 v10, v10, v26
    v_add_f32 v11, v11, v27
    v_add_f32 v12, v12, v28
    v_add_f32 v13, v13, v29
    v_add_f32 v14, v14, v30
    v_add_f32 v15, v15, v31
    s_waitcnt lgkmcnt(4)
    v_add_f32 v40, v40, v48
    v_add_f32 v41, v41, v49
    v_add_f32 v42, v42, v50
    v_add_f32 v43, v43, v51
    v_add_f32 v44, v44, v52
    v_add_f32 v45, v45, v53
    v_add_f32 v46, v46, v54
    v_add_f32 v47, v47, v55
    s_waitcnt lgkmcnt(0)
    v_add_f32 v56, v56, v64
    v_add_f32 v57, v57, v65
    v_add_f32 v58, v58, v66
    v_add_f32 v59, v59, v67
    v_add_f32 v60, v60, v68
    v_add_f32 v61, v61, v69
    v_add_f32 v62, v62, v70
    v_add_f32 v63, v63, v71
    v_add_f32 v40, v40, v56
    v_add_f32 v41, v41, v57
    v_add_f32 v42, v42, v58
    v_add_f32 v43, v43, v59
    v_add_f32 v44, v44, v60
    v_add_f32 v45, v45, v61
    v_add_f32 v46, v46, v62
    v_add_f32 v47, v47, v63
    v_mul_f32 v8, v8, v105
    v_mul_f32 v9, v9, v105
    v_mul_f32 v10, v10, v105
    v_mul_f32 v11, v11, v105
    v_mul_f32 v12, v12, v105
    v_mul_f32 v13, v13, v105
    v_mul_f32 v14, v14, v105
    v_mul_f32 v15, v15, v105
    v_fmac_f32 v8, v40, v106
    v_fmac_f32 v9, v41, v106
    v_fmac_f32 v10, v42, v106
    v_fmac_f32 v11, v43, v106
    v_fmac_f32 v12, v44, v106
    v_fmac_f32 v13, v45, v106
    v_fmac_f32 v14, v46, v106
    v_fmac_f32 v15, v47, v106
    v_cvt_pk_bf16_f32 v72, v8, v9
    v_cvt_pk_bf16_f32 v73, v10, v11
    v_cvt_pk_bf16_f32 v74, v12, v13
    v_cvt_pk_bf16_f32 v75, v14, v15
    s_nop 1
    v_permlane32_swap_b32 v72, v74
    v_permlane32_swap_b32 v73, v75
    buffer_store_dwordx4 v[72:75], v107, s[28:31], s64 offen
L_END:
    s_endpgm
L_TAGSLOW:
    s_cmp_eq_u32 s75, 0
    s_cbranch_scc1 L_TAG_OK
    buffer_load_dwordx2 v[118:119], v9, s[32:35], 0 offen sc1
    s_branch L_TAG
L_SLOW0:
    s_mov_b32 s75, 200000
L_SLOWL0:
    buffer_load_dwordx2 v[124:125], v115, s[12:15], 0 offen sc1
    s_sub_u32 s75, s75, 1
    s_waitcnt vmcnt(0)
    v_cmp_eq_u64 vcc, s[68:69], v[124:125]
    s_nop 3
    s_and_b32 s70, vcc_lo, 0xff
    s_bitcmp1_b32 s70, 2
    s_cbranch_scc1 L_FAST0
    s_cmp_lg_u32 s75, 0
    s_cbranch_scc1 L_SLOWL0
    s_branch L_FAST0
L_SLOW1:
    s_mov_b32 s75, 200000
L_SLOWL1:
    buffer_load_dwordx2 v[124:125], v115, s[12:15], 0 offen sc1
    s_sub_u32 s75, s75, 1
    s_waitcnt vmcnt(0)
    v_cmp_eq_u64 vcc, s[68:69], v[124:125]
    s_nop 3
    s_and_b32 s70, vcc_lo, 0xff
    s_bitcmp1_b32 s70, 3
    s_cbranch_scc1 L_FAST1
    s_cmp_lg_u32 s75, 0
    s_cbranch_scc1 L_SLOWL1
    s_branch L_FAST1
L_SLOW2:
    s_mov_b32 s75, 200000
L_SLOWL2:
    buffer_load_dwordx2 v[124:125], v115, s[12:15], 0 offen sc1
    s_sub_u32 s75, s75, 1
    s_waitcnt vmcnt(0)
    v_cmp_eq_u64 vcc, s[68:69], v[124:125]
    s_nop 3
    s_and_b32 s70, vcc_lo, 0xff
    s_bitcmp1_b32 s70, 4
    s_cbranch_scc1 L_FAST2
    s_cmp_lg_u32 s75, 0
    s_cbranch_scc1 L_SLOWL2
    s_branch L_FAST2
L_SLOW3:
    s_mov_b32 s75, 200000
L_SLOWL3:
    buffer_load_dwordx2 v[124:125], v115, s[12:15], 0 offen sc1
    s_sub_u32 s75, s75, 1
    s_waitcnt vmcnt(0)
    v_cmp_eq_u64 vcc, s[68:69], v[124:125]
    s_nop 3
    s_and_b32 s70, vcc_lo, 0xff
    s_bitcmp1_b32 s70, 5
    s_cbranch_scc1 L_FAST3
    s_cmp_lg_u32 s75, 0
    s_cbranch_scc1 L_SLOWL3
    s_branch L_FAST3
L_SLOW4:
    s_mov_b32 s75, 200000
L_SLOWL4:
    buffer_load_dwordx2 v[124:125], v115, s[12:15], 0 offen sc1
    s_sub_u32 s75, s75, 1
    s_waitcnt vmcnt(0)
    v_cmp_eq_u64 vcc, s[68:69], v[124:125]
    s_nop 3
    s_and_b32 s70, vcc_lo, 0xff
    s_bitcmp1_b32 s70, 6
    s_cbranch_scc1 L_FAST4
    s_cmp_lg_u32 s75, 0
    s_cbranch_scc1 L_SLOWL4
    s_branch L_FAST4
L_SLOW5:
    s_mov_b32 s75, 200000
L_SLOWL5:
    buffer_load_dwordx2 v[124:125], v115, s[12:15], 0 offen sc1
    s_sub_u32 s75, s75, 1
    s_waitcnt vmcnt(0)
    v_cmp_eq_u64 vcc, s[68:69], v[124:125]
    s_nop 3
    s_and_b32 s70, vcc_lo, 0xff
    s_bitcmp1_b32 s70, 7
    s_cbranch_scc1 L_FAST5
    s_cmp_lg_u32 s75, 0
    s_cbranch_scc1 L_SLOWL5
    s_branch L_FAST5
L_LOOP:
    v_mfma_f32_32x32x16_bf16 v[40:55], v[96:99], v[16:19], 0
    ds_read_b128 v[96:99], v112 offset:8192
    v_exp_f32 v24, v24
    v_exp_f32 v25, v25
    v_exp_f32 v26, v26
    v_exp_f32 v27, v27
    v_mfma_f32_32x32x16_bf16 v[72:87], v[108:111], v[92:95], v[72:87]
    ds_read_b128 v[108:111], v112 offset:3072
    v_cvt_pk_bf16_f32 v88, v24, v25
    v_cvt_pk_bf16_f32 v89, v26, v27
    v_exp_f32 v28, v28
    v_exp_f32 v29, v29
    v_exp_f32 v30, v30
    v_mfma_f32_32x32x16_bf16 v[40:55], v[100:103], v[20:23], v[40:55]
    ds_read_b128 v[100:103], v112 offset:9216
    v_exp_f32 v31, v31
    v_cvt_pk_bf16_f32 v90, v28, v29
    v_cvt_pk_bf16_f32 v91, v30, v31
    v_exp_f32 v32, v32
    v_exp_f32 v33, v33
    v_exp_f32 v34, v34
    s_waitcnt lgkmcnt(3)
    v_mfma_f32_32x32x16_bf16 v[56:71], v[104:107], v[88:91], v[56:71]
    v_exp_f32 v35, v35
    v_cvt_pk_bf16_f32 v92, v32, v33
    v_cvt_pk_bf16_f32 v93, v34, v35
    v_exp_f32 v36, v36
    v_exp_f32 v37, v37
    v_exp_f32 v38, v38
    v_exp_f32 v39, v39
    v_cvt_pk_bf16_f32 v94, v36, v37
    v_cvt_pk_bf16_f32 v95, v38, v39
    s_waitcnt lgkmcnt(0)
    v_mfma_f32_32x32x16_bf16 v[24:39], v[96:99], v[8:11], 0
    v_exp_f32 v40, v40
    v_exp_f32 v41, v41
    v_exp_f32 v42, v42
    v_exp_f32 v43, v43
    v_mfma_f32_32x32x16_bf16 v[56:71], v[108:111], v[92:95], v[56:71]
    v_cvt_pk_bf16_f32 v88, v40, v41
    v_cvt_pk_bf16_f32 v89, v42, v43
    v_exp_f32 v44, v44
    v_exp_f32 v45, v45
    v_exp_f32 v46, v46
    v_mfma_f32_32x32x16_bf16 v[24:39], v[100:103], v[12:15], v[24:39]
    v_exp_f32 v47, v47
    v_cvt_pk_bf16_f32 v90, v44, v45
    v_cvt_pk_bf16_f32 v91, v46, v47
    v_exp_f32 v48, v48
    v_exp_f32 v49, v49
    v_exp_f32 v50, v50
    v_mfma_f32_32x32x16_bf16 v[72:87], v[104:107], v[88:91], v[72:87]
    ds_read_b128 v[104:107], v112 offset:10240
    v_exp_f32 v51, v51
    v_cvt_pk_bf16_f32 v92, v48, v49
    v_cvt_pk_bf16_f32 v93, v50, v51
    v_exp_f32 v52, v52
    v_exp_f32 v53, v53
    v_exp_f32 v54, v54
    v_exp_f32 v55, v55
    v_cvt_pk_bf16_f32 v94, v52, v53
    v_cvt_pk_bf16_f32 v95, v54, v55
    s_setprio 0
    v_mfma_f32_32x32x16_bf16 v[40:55], v[96:99], v[16:19], 0
    ds_read_b128 v[96:99], v112 offset:16384
    v_exp_f32 v24, v24
    v_exp_f32 v25, v25
    v_exp_f32 v26, v26
    v_exp_f32 v27, v27
    v_mfma_f32_32x32x16_bf16 v[72:87], v[108:111], v[92:95], v[72:87]
    ds_read_b128 v[108:111], v112 offset:11264
    v_cvt_pk_bf16_f32 v88, v24, v25
    v_cvt_pk_bf16_f32 v89, v26, v27
    v_exp_f32 v28, v28
    v_exp_f32 v29, v29
    v_exp_f32 v30, v30
    v_mfma_f32_32x32x16_bf16 v[40:55], v[100:103], v[20:23], v[40:55]
    ds_read_b128 v[100:103], v112 offset:17408
    v_exp_f32 v31, v31
    v_cvt_pk_bf16_f32 v90, v28, v29
    v_cvt_pk_bf16_f32 v91, v30, v31
    v_exp_f32 v32, v32
    v_exp_f32 v33, v33
    v_exp_f32 v34, v34
    s_waitcnt lgkmcnt(3)
    v_mfma_f32_32x32x16_bf16 v[56:71], v[104:107], v[88:91], v[56:71]
    v_exp_f32 v35, v35
    v_cvt_pk_bf16_f32 v92, v32, v33
    v_cvt_pk_bf16_f32 v93, v34, v35
    v_exp_f32 v36, v36
    v_exp_f32 v37, v37
    v_exp_f32 v38, v38
    v_exp_f32 v39, v39
    v_cvt_pk_bf16_f32 v94, v36, v37
    v_cvt_pk_bf16_f32 v95, v38, v39
    s_waitcnt lgkmcnt(0)
    v_mfma_f32_32x32x16_bf16 v[24:39], v[96:99], v[8:11], 0
    v_exp_f32 v40, v40
    v_exp_f32 v41, v41
    v_exp_f32 v42, v42
    v_exp_f32 v43, v43
    v_mfma_f32_32x32x16_bf16 v[56:71], v[108:111], v[92:95], v[56:71]
    v_cvt_pk_bf16_f32 v88, v40, v41
    v_cvt_pk_bf16_f32 v89, v42, v43
    v_exp_f32 v44, v44
    v_exp_f32 v45, v45
    v_exp_f32 v46, v46
    v_mfma_f32_32x32x16_bf16 v[24:39], v[100:103], v[12:15], v[24:39]
    v_exp_f32 v47, v47
    v_cvt_pk_bf16_f32 v90, v44, v45
    v_cvt_pk_bf16_f32 v91, v46, v47
    v_exp_f32 v48, v48
    v_exp_f32 v49, v49
    v_exp_f32 v50, v50
    v_mfma_f32_32x32x16_bf16 v[72:87], v[104:107], v[88:91], v[72:87]
    ds_read_b128 v[104:107], v112 offset:18432
    v_exp_f32 v51, v51
    v_cvt_pk_bf16_f32 v92, v48, v49
    v_cvt_pk_bf16_f32 v93, v50, v51
    v_exp_f32 v52, v52
    v_exp_f32 v53, v53
    v_exp_f32 v54, v54
    v_exp_f32 v55, v55
    v_cvt_pk_bf16_f32 v94, v52, v53
    v_cvt_pk_bf16_f32 v95, v54, v55
    v_mfma_f32_32x32x16_bf16 v[40:55], v[96:99], v[16:19], 0
    ds_read_b128 v[96:99], v112 offset:24576
    v_exp_f32 v24, v24
    v_exp_f32 v25, v25
    v_exp_f32 v26, v26
    v_exp_f32 v27, v27
    v_mfma_f32_32x32x16_bf16 v[72:87], v[108:111], v[92:95], v[72:87]
    ds_read_b128 v[108:111], v112 offset:19456
    v_cvt_pk_bf16_f32 v88, v24, v25
    v_cvt_pk_bf16_f32 v89, v26, v27
    v_exp_f32 v28, v28
    v_exp_f32 v29, v29
    v_exp_f32 v30, v30
    v_mfma_f32_32x32x16_bf16 v[40:55], v[100:103], v[20:23], v[40:55]
    ds_read_b128 v[100:103], v112 offset:25600
    v_exp_f32 v31, v31
    v_cvt_pk_bf16_f32 v90, v28, v29
    v_cvt_pk_bf16_f32 v91, v30, v31
    v_exp_f32 v32, v32
    v_exp_f32 v33, v33
    v_exp_f32 v34, v34
    s_waitcnt lgkmcnt(3)
    v_mfma_f32_32x32x16_bf16 v[56:71], v[104:107], v[88:91], v[56:71]
    v_exp_f32 v35, v35
    v_cvt_pk_bf16_f32 v92, v32, v33
    v_cvt_pk_bf16_f32 v93, v34, v35
    v_exp_f32 v36, v36
    v_exp_f32 v37, v37
    v_exp_f32 v38, v38
    v_exp_f32 v39, v39
    v_cvt_pk_bf16_f32 v94, v36, v37
    v_cvt_pk_bf16_f32 v95, v38, v39
    s_waitcnt lgkmcnt(0)
    v_mfma_f32_32x32x16_bf16 v[24:39], v[96:99], v[8:11], 0
    v_exp_f32 v40, v40
    v_exp_f32 v41, v41
    v_exp_f32 v42, v42
    v_exp_f32 v43, v43
    v_mfma_f32_32x32x16_bf16 v[56:71], v[108:111], v[92:95], v[56:71]
    v_cvt_pk_bf16_f32 v88, v40, v41
    v_cvt_pk_bf16_f32 v89, v42, v43
    v_exp_f32 v44, v44
    v_exp_f32 v45, v45
    v_exp_f32 v46, v46
    v_mfma_f32_32x32x16_bf16 v[24:39], v[100:103], v[12:15], v[24:39]
    v_exp_f32 v47, v47
    v_cvt_pk_bf16_f32 v90, v44, v45
    v_cvt_pk_bf16_f32 v91, v46, v47
    v_exp_f32 v48, v48
    v_exp_f32 v49, v49
    v_exp_f32 v50, v50
    v_mfma_f32_32x32x16_bf16 v[72:87], v[104:107], v[88:91], v[72:87]
    ds_read_b128 v[104:107], v112 offset:26624
    v_exp_f32 v51, v51
    v_cvt_pk_bf16_f32 v92, v48, v49
    v_cvt_pk_bf16_f32 v93, v50, v51
    v_exp_f32 v52, v52
    v_exp_f32 v53, v53
    v_exp_f32 v54, v54
    v_exp_f32 v55, v55
    v_cvt_pk_bf16_f32 v94, v52, v53
    v_cvt_pk_bf16_f32 v95, v54, v55
    s_waitcnt vmcnt(0) lgkmcnt(0)
    s_barrier
    s_setprio 1
    v_mfma_f32_32x32x16_bf16 v[40:55], v[96:99], v[16:19], 0
    ds_read_b128 v[96:99], v113 offset:0
    v_exp_f32 v24, v24
    v_exp_f32 v25, v25
    v_exp_f32 v26, v26
    v_exp_f32 v27, v27
    v_mfma_f32_32x32x16_bf16 v[72:87], v[108:111], v[92:95], v[72:87]
    ds_read_b128 v[108:111], v112 offset:27648
    v_cvt_pk_bf16_f32 v88, v24, v25
    v_cvt_pk_bf16_f32 v89, v26, v27
    v_exp_f32 v28, v28
    v_exp_f32 v29, v29
    v_exp_f32 v30, v30
    v_mfma_f32_32x32x16_bf16 v[40:55], v[100:103], v[20:23], v[40:55]
    ds_read_b128 v[100:103], v113 offset:1024
    v_exp_f32 v31, v31
    v_cvt_pk_bf16_f32 v90, v28, v29
    v_cvt_pk_bf16_f32 v91, v30, v31
    v_exp_f32 v32, v32
    v_exp_f32 v33, v33
    v_exp_f32 v34, v34
    s_waitcnt lgkmcnt(3)
    v_mfma_f32_32x32x16_bf16 v[56:71], v[104:107], v[88:91], v[56:71]
    v_exp_f32 v35, v35
    v_cvt_pk_bf16_f32 v92, v32, v33
    v_cvt_pk_bf16_f32 v93, v34, v35
    s_cmp_lg_u32 s48, 0
    s_cbranch_scc1 L_NODMA6L
    s_cmp_eq_u32 s50, 0
    s_cbranch_scc1 L_NODMA6L
    s_mov_b32 s75, 200000
L_P26L:
    s_sub_u32 s64, 0, s50
    s_and_b32 s64, s64, s50
    s_and_b32 s64, s64, s70
    s_cbranch_scc1 L_P26L_OK
    buffer_load_dwordx2 v[124:125], v115, s[12:15], 0 offen sc1
    s_sub_u32 s75, s75, 1
    s_waitcnt vmcnt(0)
    v_cmp_eq_u64 vcc, s[68:69], v[124:125]
    s_nop 3
    s_and_b32 s70, vcc_lo, 0xff
    s_cmp_lg_u32 s75, 0
    s_cbranch_scc1 L_P26L
    s_mov_b32 s64, s50
L_P26L_OK:
    s_ff1_i32_b32 s64, s64
    s_bitset0_b32 s50, s64
    s_add_u32 s62, s57, s64
    s_and_b32 s62, s62, 7
    s_add_u32 m0, s74, s76
    s_lshl_b32 s62, s62, 15
    buffer_load_dwordx4 v114, s[24:27], s62 offen offset:0 sc1 lds
    buffer_load_dwordx4 v114, s[24:27], s62 offen offset:1024 sc1 lds
    buffer_load_dwordx4 v114, s[24:27], s62 offen offset:2048 sc1 lds
    buffer_load_dwordx4 v114, s[24:27], s62 offen offset:3072 sc1 lds
L_NODMA6L:
    v_exp_f32 v36, v36
    v_exp_f32 v37, v37
    v_exp_f32 v38, v38
    v_exp_f32 v39, v39
    v_cvt_pk_bf16_f32 v94, v36, v37
    v_cvt_pk_bf16_f32 v95, v38, v39
    s_waitcnt lgkmcnt(0)
    v_mfma_f32_32x32x16_bf16 v[24:39], v[96:99], v[8:11], 0
    v_exp_f32 v40, v40
    v_exp_f32 v41, v41
    v_exp_f32 v42, v42
    v_exp_f32 v43, v43
    v_mfma_f32_32x32x16_bf16 v[56:71], v[108:111], v[92:95], v[56:71]
    v_cvt_pk_bf16_f32 v88, v40, v41
    v_cvt_pk_bf16_f32 v89, v42, v43
    v_exp_f32 v44, v44
    v_exp_f32 v45, v45
    v_exp_f32 v46, v46
    v_mfma_f32_32x32x16_bf16 v[24:39], v[100:103], v[12:15], v[24:39]
    v_exp_f32 v47, v47
    v_cvt_pk_bf16_f32 v90, v44, v45
    v_cvt_pk_bf16_f32 v91, v46, v47
    v_exp_f32 v48, v48
    v_exp_f32 v49, v49
    v_exp_f32 v50, v50
    v_mfma_f32_32x32x16_bf16 v[72:87], v[104:107], v[88:91], v[72:87]
    ds_read_b128 v[104:107], v113 offset:2048
    v_exp_f32 v51, v51
    v_cvt_pk_bf16_f32 v92, v48, v49
    v_cvt_pk_bf16_f32 v93, v50, v51
    s_cmp_lg_u32 s48, 1
    s_cbranch_scc1 L_NODMA7L
    s_cmp_eq_u32 s50, 0
    s_cbranch_scc1 L_NODMA7L
    s_mov_b32 s75, 200000
L_P27L:
    s_sub_u32 s64, 0, s50
    s_and_b32 s64, s64, s50
    s_and_b32 s64, s64, s70
    s_cbranch_scc1 L_P27L_OK
    buffer_load_dwordx2 v[124:125], v115, s[12:15], 0 offen sc1
    s_sub_u32 s75, s75, 1
    s_waitcnt vmcnt(0)
    v_cmp_eq_u64 vcc, s[68:69], v[124:125]
    s_nop 3
    s_and_b32 s70, vcc_lo, 0xff
    s_cmp_lg_u32 s75, 0
    s_cbranch_scc1 L_P27L
    s_mov_b32 s64, s50
L_P27L_OK:
    s_ff1_i32_b32 s64, s64
    s_bitset0_b32 s50, s64
    s_add_u32 s62, s57, s64
    s_and_b32 s62, s62, 7
    s_add_u32 m0, s74, s76
    s_lshl_b32 s62, s62, 15
    buffer_load_dwordx4 v114, s[24:27], s62 offen offset:0 sc1 lds
    buffer_load_dwordx4 v114, s[24:27], s62 offen offset:1024 sc1 lds
    buffer_load_dwordx4 v114, s[24:27], s62 offen offset:2048 sc1 lds
    buffer_load_dwordx4 v114, s[24:27], s62 offen offset:3072 sc1 lds
L_NODMA7L:
    s_mov_b32 s59, s72
    s_mov_b32 s72, s73
    s_mov_b32 s73, s74
    s_mov_b32 s74, s59
    v_add_u32 v112, s72, v120
    v_add_u32 v113, s73, v120
    s_add_u32 s71, s71, 1
    s_cmp_lt_u32 s71, 8
    v_exp_f32 v52, v52
    v_exp_f32 v53, v53
    v_exp_f32 v54, v54
    v_exp_f32 v55, v55
    v_cvt_pk_bf16_f32 v94, v52, v53
    v_cvt_pk_bf16_f32 v95, v54, v55
    s_cbranch_scc1 L_LOOP
    s_xor_b32 s62, s76, 16384
    s_add_u32 s62, s62, 126976
    v_add_u32 v4, s62, v3
    ds_write_b128 v4, v[56:59] offset:0
    ds_write_b128 v4, v[60:63] offset:1024
    ds_write_b128 v4, v[64:67] offset:2048
    ds_write_b128 v4, v[68:71] offset:3072
    s_branch L_POST
L_FALLBACK:
    s_mov_b32 s77, 64
    s_mov_b32 exec_lo, 0
    v_mov_b32 v14, 0
    v_mov_b32 v15, 0
    v_mov_b32 v22, 0
    v_mov_b32 v23, 0
    s_mov_b32 exec_lo, -1
    v_mov_b32 v4, 0xff800000
    v_mov_b32 v5, 0xff800000
    s_mov_b32 s62, 0
    s_waitcnt vmcnt(0) lgkmcnt(0)
    s_barrier
L_FBMAX:
    buffer_load_dwordx4 v[96:99], v3, s[24:27], s62 offen sc1
    buffer_load_dwordx4 v[100:103], v3, s[24:27], s62 offen offset:1024 sc1
    s_waitcnt vmcnt(0)
    v_mfma_f32_32x32x16_bf16 v[24:39], v[96:99], v[8:11], 0
    v_mfma_f32_32x32x16_bf16 v[24:39], v[100:103], v[12:15], v[24:39]
    v_mfma_f32_32x32x16_bf16 v[40:55], v[96:99], v[16:19], 0
    v_mfma_f32_32x32x16_bf16 v[40:55], v[100:103], v[20:23], v[40:55]
    s_nop 15
    v_max3_f32 v4, v4, v24, v25
    v_max3_f32 v4, v4, v26, v27
    v_max3_f32 v4, v4, v28, v29
    v_max3_f32 v4, v4, v30, v31
    v_max3_f32 v4, v4, v32, v33
    v_max3_f32 v4, v4, v34, v35
    v_max3_f32 v4, v4, v36, v37
    v_max3_f32 v4, v4, v38, v39
    v_max3_f32 v5, v5, v40, v41
    v_max3_f32 v5, v5, v42, v43
    v_max3_f32 v5, v5, v44, v45
    v_max3_f32 v5, v5, v46, v47
    v_max3_f32 v5, v5, v48, v49
    v_max3_f32 v5, v5, v50, v51
    v_max3_f32 v5, v5, v52, v53
    v_max3_f32 v5, v5, v54, v55
    s_add_u32 s62, s62, 4096
    s_cmp_lt_u32 s62, 262144
    s_cbranch_scc1 L_FBMAX
    s_mov_b32 s72, 126976
    s_mov_b32 s73, 0
    s_movk_i32 s50, 0xff
    s_movk_i32 s70, 0xff
    s_mov_b32 s64, 1
    s_ff1_i32_b32 s64, s64
    s_bitset0_b32 s50, s64
    s_add_u32 s62, s57, s64
    s_and_b32 s62, s62, 7
    s_add_u32 m0, s72, s76
    s_lshl_b32 s62, s62, 15
    buffer_load_dwordx4 v114, s[24:27], s62 offen offset:0 sc1 lds
    buffer_load_dwordx4 v114, s[24:27], s62 offen offset:1024 sc1 lds
    buffer_load_dwordx4 v114, s[24:27], s62 offen offset:2048 sc1 lds
    buffer_load_dwordx4 v114, s[24:27], s62 offen offset:3072 sc1 lds
    s_mov_b32 s64, 2
    s_ff1_i32_b32 s64, s64
    s_bitset0_b32 s50, s64
    s_add_u32 s62, s57, s64
    s_and_b32 s62, s62, 7
    s_add_u32 m0, s73, s76
    s_lshl_b32 s62, s62, 15
    buffer_load_dwordx4 v114, s[24:27], s62 offen offset:0 sc1 lds
    buffer_load_dwordx4 v114, s[24:27], s62 offen offset:1024 sc1 lds
    buffer_load_dwordx4 v114, s[24:27], s62 offen offset:2048 sc1 lds
    buffer_load_dwordx4 v114, s[24:27], s62 offen offset:3072 sc1 lds
    v_mov_b32 v6, v4
    v_mov_b32 v7, v5
    s_nop 1
    v_permlane32_swap_b32 v4, v6
    v_permlane32_swap_b32 v5, v7
    s_nop 0
    v_max_f32 v4, v4, v6
    v_max_f32 v5, v5, v7
    v_sub_f32 v4, 0, v4
    v_and_b32 v6, 0xffff0000, v4
    v_sub_f32 v4, v4, v6
    v_and_b32 v7, 0xffff0000, v4
    v_sub_f32 v4, v4, v7
    v_lshrrev_b32 v6, 16, v6
    s_mov_b32 exec_lo, 0
    v_or_b32 v14, v6, v7
    v_lshrrev_b32 v15, 16, v4
    s_mov_b32 exec_lo, -1
    v_sub_f32 v5, 0, v5
    v_and_b32 v6, 0xffff0000, v5
    v_sub_f32 v5, v5, v6
    v_and_b32 v7, 0xffff0000, v5
    v_sub_f32 v5, v5, v7
    v_lshrrev_b32 v6, 16, v6
    s_mov_b32 exec_lo, 0
    v_or_b32 v22, v6, v7
    v_lshrrev_b32 v23, 16, v5
    s_mov_b32 exec_lo, -1
    s_waitcnt vmcnt(4)
    s_barrier
    s_branch L_PRIME
L_CODE_END:

.section .rodata,"a"
.p2align 6
.amdhsa_kernel gated_mix__softmax_full_mha__softmax_full_mha__prompt_kernel
  .amdhsa_next_free_vgpr 256
  .amdhsa_next_free_sgpr 78
  .amdhsa_accum_offset 128
  .amdhsa_group_segment_fixed_size 0
  .amdhsa_kernarg_size 80
  .amdhsa_user_sgpr_count 2
  .amdhsa_user_sgpr_kernarg_segment_ptr 1
  .amdhsa_system_sgpr_workgroup_id_x 1
.end_amdhsa_kernel
```
